```python
import torch

def _softmax(x, axis=-1):
    return torch.softmax(x, dim=axis)
def _gelu(x):
    return torch.nn.functional.gelu(x, approximate="tanh")
def _silu(x):
    return torch.nn.functional.silu(x)
def _sigmoid(x):
    return torch.sigmoid(x)
def _layernorm(x, axis=-1, eps=1e-5):
    m = x.mean(dim=axis, keepdim=True)
    v = x.var(dim=axis, keepdim=True, unbiased=False)
    return (x - m) / torch.sqrt(v + eps)
def _scatter_add(tgt, idx, src, axis=0):
    return tgt.clone().index_add_(axis, idx, src)
def _segment_sum(src, seg, n):
    out = torch.zeros((n,) + src.shape[1:], dtype=src.dtype)
    return out.index_add_(0, seg, src)
def _pad(x, pw):
    flat = tuple(v for pair in reversed(pw) for v in pair)
    return torch.nn.functional.pad(x, flat)

kernel_name = 'concat_heads__softmax_full_mha__ssm_conv_s4__prompt'

def setup_inputs():

    _w = (lambda a: (lambda t: t.to(torch.bfloat16) if t.is_floating_point() else t)(torch.as_tensor(a)))
    def _A_setup():
        B, S, D = 1, 2048, 512
        return {
            "x": _w((lambda *s: torch.randn(*s, dtype=torch.bfloat16) * 0.2)(B, S, D)),
            "wqkv": _w((lambda *s: torch.randn(*s, dtype=torch.bfloat16) * 0.2)(D, 3 * D)),
            "wo": _w((lambda *s: torch.randn(*s, dtype=torch.bfloat16) * 0.05)(D, D)),
        }
    _A_in = _A_setup()

    def _B_setup():
        B, L, D, N = 1, 2048, 512, 128
        A_re = -(lambda _x: torch.exp(torch.as_tensor(_x)))((lambda *s: torch.randn(*s, dtype=torch.bfloat16) * 6.4)(D, N))
        A_im = torch.pi * (lambda *s: torch.randn(*s, dtype=torch.bfloat16) * 0.1)(D, N)
        B_re = (lambda *s: torch.randn(*s, dtype=torch.bfloat16) * 0.2)(D, N)
        B_im = (lambda *s: torch.randn(*s, dtype=torch.bfloat16) * 0.2)(D, N)
        C_re = (lambda *s: torch.randn(*s, dtype=torch.bfloat16) * 0.2)(D, N)
        C_im = (lambda *s: torch.randn(*s, dtype=torch.bfloat16) * 0.2)(D, N)
        log_dt = (lambda *s: torch.randn(*s, dtype=torch.bfloat16) * 0.1)(D) * 0.5 - 4.0
        Dskip = (lambda *s: torch.randn(*s, dtype=torch.bfloat16) * 0.1)(D)
        return {
            "u": _w((lambda *s: torch.randn(*s, dtype=torch.bfloat16) * 0.05)(B, L, D)),
            "A_re": _w(A_re),
            "A_im": _w(A_im),
            "B_re": _w(B_re),
            "B_im": _w(B_im),
            "C_re": _w(C_re),
            "C_im": _w(C_im),
            "log_dt": _w(log_dt),
            "Dskip": _w(Dskip),
        }
    _B_in = _B_setup()

    return {
        "A_x": _A_in["x"],
        "A_wqkv": _A_in["wqkv"],
        "A_wo": _A_in["wo"],
        "B_u": _B_in["u"],
        "B_A_re": _B_in["A_re"],
        "B_A_im": _B_in["A_im"],
        "B_B_re": _B_in["B_re"],
        "B_B_im": _B_in["B_im"],
        "B_C_re": _B_in["C_re"],
        "B_C_im": _B_in["C_im"],
        "B_log_dt": _B_in["log_dt"],
        "B_Dskip": _B_in["Dskip"],
    }

def reference(A_x, A_wqkv, A_wo, B_u, B_A_re, B_A_im, B_B_re, B_B_im, B_C_re, B_C_im, B_log_dt, B_Dskip):
    def _A_ref(x, wqkv, wo):
        B, S, D = x.shape
        H = 32; Dh = D // H
        qkv = (lambda x, *d: x.permute(*d))((x @ wqkv).reshape(B, S, 3, H, Dh), 2, 0, 3, 1, 4)
        q, k, v = qkv[0], qkv[1], qkv[2]
        scale = Dh ** -0.5
        scores = torch.einsum("bhqd,bhkd->bhqk", q, k) * scale
        p = _softmax(scores, axis=-1)
        o = torch.einsum("bhqk,bhkd->bhqd", p, v)
        return (lambda x, *d: x.permute(*d))(o, 0, 2, 1, 3).reshape(B, S, D) @ wo

    def _B_ref(u, A_re, A_im, B_re, B_im, C_re, C_im, log_dt, Dskip):
        Bsz, L, D = u.shape
        dt = torch.exp(log_dt)[:, None]
        A = A_re + 1j * A_im
        Bc = B_re + 1j * B_im
        Cc = C_re + 1j * C_im
        logdA = dt * A
        dB = dt * Bc
        l = (lambda x, dt: x.to(dt))(torch.arange(L), A_re.dtype)
        P = torch.exp(logdA[:, :, None] * l[None, None, :])
        K = torch.einsum("dn,dnl,dn->dl", Cc, P, dB).real
        L2 = 2 * L
        Kp = _pad(K, ((0, 0), (0, L)))
        up = (lambda x, *d: x.permute(*d))(u, 0, 2, 1)
        up = _pad(up, ((0, 0), (0, 0), (0, L)))
        Kf = (lambda x, axes=(-2,-1): torch.fft.rfft2(x.float(), dim=axes))(Kp[:, None, :], axes=(-2, -1))
        Uf = (lambda x, axes=(-2,-1): torch.fft.rfft2(x.float(), dim=axes))(up[:, :, None, :], axes=(-2, -1))
        Yf = Uf * Kf[None, :, :, :]
        y = (lambda x, s, axes=(-2,-1): torch.fft.irfft2(x, s=s, dim=axes).to(torch.bfloat16))(Yf, (1, L2), axes=(-2, -1))[:, :, 0, :L]
        y = (lambda x, *d: x.permute(*d))(y, 0, 2, 1) + u * Dskip[None, None, :]
        return y

    a = _A_ref(A_x, A_wqkv, A_wo)
    b = _B_ref(B_u, B_A_re, B_A_im, B_B_re, B_B_im, B_C_re, B_C_im, B_log_dt, B_Dskip)
    return torch.concatenate([a, b], axis=-1)
```

```asm
; @launch grid=(256,1,1) block=(512,1,1) lds=160832
.amdgcn_target "amdgcn-amd-amdhsa--gfx950"
.text
.globl concat_heads__softmax_full_mha__ssm_conv_s4__prompt_kernel
.p2align 8
.type concat_heads__softmax_full_mha__ssm_conv_s4__prompt_kernel,@function
concat_heads__softmax_full_mha__ssm_conv_s4__prompt_kernel:
    s_cmp_ge_u32 s2, 256
    s_cbranch_scc1 K_END
    s_load_dwordx4 s[4:7], s[0:1], 0
    v_readfirstlane_b32 s3, v0
    v_and_b32 v0, 63, v0
    s_and_b32 s24, s2, 7
    s_lshr_b32 s25, s2, 3
    s_lshr_b32 s3, s3, 6
    s_and_b32 s26, s2, 6
    s_lshl_b32 s26, s26, 2
    s_and_b32 s31, s25, 7
    s_add_u32 s26, s26, s31
    s_lshr_b32 s30, s2, 6
    s_and_b32 s27, s2, 1
    s_lshl_b32 s27, s27, 2
    s_add_u32 s27, s27, s30
    s_lshl_b32 s30, s30, 0
    s_add_u32 s31, s31, s30
    s_mul_i32 s31, s31, 2
    s_lshl_b32 s53, s3, 12
    s_lshl_b32 s50, s26, 16
    s_lshl_b32 s51, s3, 15
    s_add_u32 s50, s50, s51
    s_sub_u32 s48, s3, 2
    s_lshr_b32 s49, s48, 1
    s_lshl_b32 s49, s49, 10
    s_and_b32 s48, s48, 1
    s_mul_i32 s48, s48, 98304
    s_add_u32 s48, s48, s49
    s_lshl_b32 s49, s27, 7
    s_add_u32 s48, s48, s49
    s_cmp_lt_u32 s3, 2
    s_cselect_b32 s50, s50, s48
    s_cselect_b32 s55, 1, 3
    s_mul_i32 s55, s55, 1024
    s_mul_i32 s51, s55, 8
    s_mul_i32 s52, s55, 64
    s_mul_i32 s14, s55, 512
    s_cselect_b32 s52, 128, s52
    s_cselect_b32 s14, 2097152, s14
    s_cselect_b32 s48, 3, 1
    s_cselect_b32 s49, 0, 1
    v_lshrrev_b32 v3, 4, v0
    v_lshrrev_b32 v10, 3, v0
    v_and_b32 v76, s48, v3
    v_lshlrev_b32 v76, s49, v76
    v_and_b32 v11, 7, v0
    v_xor_b32 v76, v76, v11
    v_mul_u32_u24 v77, s55, v10
    v_lshl_add_u32 v76, v76, 4, v77
    v_xor_b32 v77, 64, v76
    s_mov_b32 s15, 0x00020000
    s_waitcnt lgkmcnt(0)
    s_cselect_b32 s12, s4, s6
    s_cselect_b32 s13, s5, s7
    s_add_u32 m0, s53, 0
    s_add_u32 s54, s31, 0
    s_and_b32 s54, s54, 7
    s_mul_i32 s54, s54, s52
    s_add_u32 s54, s54, s50
    buffer_load_dwordx4 v76, s[12:15], s54 offen lds
    s_add_u32 m0, m0, 1024
    s_add_u32 s54, s54, s51
    buffer_load_dwordx4 v77, s[12:15], s54 offen lds
    s_add_u32 m0, m0, 1024
    s_add_u32 s54, s54, s51
    buffer_load_dwordx4 v76, s[12:15], s54 offen lds
    s_add_u32 m0, m0, 1024
    s_add_u32 s54, s54, s51
    buffer_load_dwordx4 v77, s[12:15], s54 offen lds
    s_load_dwordx2 s[28:29], s[0:1], 112
    s_load_dwordx16 s[32:47], s[0:1], 32
    v_and_b32 v2, 15, v0
    s_and_b32 s30, s3, 1
    s_lshr_b32 s48, s3, 1
    s_barrier
    s_cmp_lt_u32 s3, 4
    s_cbranch_scc1 P1_NP
    s_setprio 1
    s_getpc_b64 s[8:9]
P1_PC:
    s_and_b32 s55, s3, 3
    s_lshl_b32 s55, s55, 12
    v_lshl_add_u32 v78, v0, 6, s55
    v_min_u32 v78, K_END-P1_PC, v78
    global_load_dword v87, v78, s[8:9]
    s_lshl_b32 s56, s24, 5
    s_add_u32 s56, s56, s25
    s_lshl_b32 s56, s56, 1
    s_and_b32 s55, s48, 1
    s_add_u32 s56, s56, s55
    s_lshl_b32 s58, s56, 8
    s_lshl_b32 s59, s30, 7
    s_add_u32 s58, s58, s59
    v_lshl_add_u32 v10, v0, 1, s58
    s_lshl_b32 s59, s56, 1
    v_mov_b32 v11, s59
    s_waitcnt lgkmcnt(0)
    global_load_ushort v86, v11, s[44:45]
    global_load_ushort v80, v10, s[32:33]
    global_load_ushort v81, v10, s[34:35]
    global_load_ushort v82, v10, s[36:37]
    global_load_ushort v83, v10, s[38:39]
    global_load_ushort v84, v10, s[40:41]
    global_load_ushort v85, v10, s[42:43]
P1_NP:
    s_add_u32 m0, s53, 32768
    s_add_u32 s54, s31, 1
    s_and_b32 s54, s54, 7
    s_mul_i32 s54, s54, s52
    s_add_u32 s54, s54, s50
    buffer_load_dwordx4 v76, s[12:15], s54 offen lds
    s_add_u32 m0, m0, 1024
    s_add_u32 s54, s54, s51
    buffer_load_dwordx4 v77, s[12:15], s54 offen lds
    s_add_u32 m0, m0, 1024
    s_add_u32 s54, s54, s51
    buffer_load_dwordx4 v76, s[12:15], s54 offen lds
    s_add_u32 m0, m0, 1024
    s_add_u32 s54, s54, s51
    buffer_load_dwordx4 v77, s[12:15], s54 offen lds
    s_waitcnt lgkmcnt(0)
    s_mov_b32 s20, s28
    s_mov_b32 s21, s29
    s_mov_b32 s22, 0x2000000
    s_mov_b32 s23, 0x00020000
    s_add_u32 s8, s28, 0xd00000
    s_addc_u32 s9, s29, 0
    s_load_dwordx2 s[100:101], s[8:9], 0
    v_lshlrev_b32 v1, 4, v0
    v_lshrrev_b32 v78, 1, v2
    v_xor_b32 v78, v78, v3
    v_lshlrev_b32 v78, 4, v78
    v_lshl_add_u32 v4, v2, 7, v78
    s_lshl_b32 s49, s30, 12
    v_add_u32 v4, s49, v4
    v_xor_b32 v5, 64, v4
    v_add_u32 v6, 65536, v4
    v_add_u32 v7, 65536, v5
    v_bfe_u32 v78, v0, 2, 2
    v_lshl_add_u32 v78, v3, 3, v78
    v_lshlrev_b32 v78, 7, v78
    v_bfe_u32 v79, v0, 3, 2
    v_xor_b32 v79, s48, v79
    v_lshl_add_u32 v78, v79, 5, v78
    v_and_b32 v79, 3, v0
    v_lshl_add_u32 v8, v79, 3, v78
    v_add_u32 v8, 8192, v8
    v_add_u32 v9, 65536, v8
P1_NW:
    v_mov_b32 v12, 0
    v_mov_b32 v13, 0
    v_mov_b32 v14, 0
    v_mov_b32 v15, 0
    v_mov_b32 v16, 0
    v_mov_b32 v17, 0
    v_mov_b32 v18, 0
    v_mov_b32 v19, 0
    v_mov_b32 v20, 0
    v_mov_b32 v21, 0
    v_mov_b32 v22, 0
    v_mov_b32 v23, 0
    v_mov_b32 v24, 0
    v_mov_b32 v25, 0
    v_mov_b32 v26, 0
    v_mov_b32 v27, 0
    v_mov_b32 v28, 0
    v_mov_b32 v29, 0
    v_mov_b32 v30, 0
    v_mov_b32 v31, 0
    v_mov_b32 v32, 0
    v_mov_b32 v33, 0
    v_mov_b32 v34, 0
    v_mov_b32 v35, 0
    s_cmp_lt_u32 s3, 4
    s_cbranch_scc1 P1_W0
    s_waitcnt vmcnt(12) lgkmcnt(0)
    s_branch P1_W1
P1_W0:
    s_waitcnt vmcnt(4) lgkmcnt(0)
P1_W1:
    s_barrier
    s_add_u32 s100, s100, 0x7f4a7c15
    s_addc_u32 s101, s101, 0x9e3779b9
    ds_read_b128 v[36:39], v4 offset:0
    ds_read_b128 v[40:43], v4 offset:2048
    ds_read_b64_tr_b16 v[44:45], v8 offset:0
    ds_read_b64_tr_b16 v[46:47], v8 offset:512
    ds_read_b64_tr_b16 v[48:49], v8 offset:8192
    ds_read_b64_tr_b16 v[50:51], v8 offset:8704
    ds_read_b64_tr_b16 v[52:53], v8 offset:16384
    ds_read_b64_tr_b16 v[54:55], v8 offset:16896
    ds_read_b128 v[56:59], v5 offset:0
    ds_read_b128 v[60:63], v5 offset:2048
    ds_read_b64_tr_b16 v[64:65], v8 offset:4096
    ds_read_b64_tr_b16 v[66:67], v8 offset:4608
    ds_read_b64_tr_b16 v[68:69], v8 offset:12288
    ds_read_b64_tr_b16 v[70:71], v8 offset:12800
    ds_read_b64_tr_b16 v[72:73], v8 offset:20480
    ds_read_b64_tr_b16 v[74:75], v8 offset:20992
    s_add_u32 m0, s53, 65536
    s_add_u32 s54, s31, 2
    s_and_b32 s54, s54, 7
    s_mul_i32 s54, s54, s52
    s_add_u32 s54, s54, s50
    buffer_load_dwordx4 v76, s[12:15], s54 offen lds
    s_add_u32 m0, m0, 1024
    s_add_u32 s54, s54, s51
    buffer_load_dwordx4 v77, s[12:15], s54 offen lds
    s_add_u32 m0, m0, 1024
    s_add_u32 s54, s54, s51
    buffer_load_dwordx4 v76, s[12:15], s54 offen lds
    s_add_u32 m0, m0, 1024
    s_add_u32 s54, s54, s51
    buffer_load_dwordx4 v77, s[12:15], s54 offen lds
    s_waitcnt vmcnt(4) lgkmcnt(0)
    s_barrier
    v_mfma_f32_16x16x32_bf16 v[20:23], v[48:51], v[36:39], v[20:23]
    ds_read_b128 v[180:183], v4 offset:32768
    ds_read_b128 v[184:187], v4 offset:34816
    v_mfma_f32_16x16x32_bf16 v[24:27], v[48:51], v[40:43], v[24:27]
    ds_read_b64_tr_b16 v[188:189], v8 offset:32768
    ds_read_b64_tr_b16 v[190:191], v8 offset:33280
    v_mfma_f32_16x16x32_bf16 v[28:31], v[36:39], v[52:55], v[28:31]
    ds_read_b64_tr_b16 v[192:193], v8 offset:40960
    ds_read_b64_tr_b16 v[194:195], v8 offset:41472
    v_mfma_f32_16x16x32_bf16 v[32:35], v[40:43], v[52:55], v[32:35]
    ds_read_b64_tr_b16 v[196:197], v8 offset:49152
    ds_read_b64_tr_b16 v[198:199], v8 offset:49664
    v_mfma_f32_16x16x32_bf16 v[12:15], v[44:47], v[36:39], v[12:15]
    ds_read_b128 v[200:203], v5 offset:32768
    ds_read_b128 v[204:207], v5 offset:34816
    v_mfma_f32_16x16x32_bf16 v[16:19], v[44:47], v[40:43], v[16:19]
    ds_read_b64_tr_b16 v[208:209], v8 offset:36864
    ds_read_b64_tr_b16 v[210:211], v8 offset:37376
    v_mfma_f32_16x16x32_bf16 v[20:23], v[68:71], v[56:59], v[20:23]
    ds_read_b64_tr_b16 v[212:213], v8 offset:45056
    ds_read_b64_tr_b16 v[214:215], v8 offset:45568
    v_mfma_f32_16x16x32_bf16 v[24:27], v[68:71], v[60:63], v[24:27]
    ds_read_b64_tr_b16 v[216:217], v8 offset:53248
    ds_read_b64_tr_b16 v[218:219], v8 offset:53760
    v_mfma_f32_16x16x32_bf16 v[28:31], v[56:59], v[72:75], v[28:31]
    s_add_u32 m0, s53, 98304
    s_add_u32 s54, s31, 3
    s_and_b32 s54, s54, 7
    s_mul_i32 s54, s54, s52
    s_add_u32 s54, s54, s50
    buffer_load_dwordx4 v76, s[12:15], s54 offen lds
    v_mfma_f32_16x16x32_bf16 v[32:35], v[60:63], v[72:75], v[32:35]
    s_add_u32 m0, m0, 1024
    s_add_u32 s54, s54, s51
    buffer_load_dwordx4 v77, s[12:15], s54 offen lds
    v_mfma_f32_16x16x32_bf16 v[12:15], v[64:67], v[56:59], v[12:15]
    s_add_u32 m0, m0, 1024
    s_add_u32 s54, s54, s51
    buffer_load_dwordx4 v76, s[12:15], s54 offen lds
    v_mfma_f32_16x16x32_bf16 v[16:19], v[64:67], v[60:63], v[16:19]
    s_add_u32 m0, m0, 1024
    s_add_u32 s54, s54, s51
    buffer_load_dwordx4 v77, s[12:15], s54 offen lds
    s_waitcnt vmcnt(4) lgkmcnt(0)
    s_barrier
    v_mfma_f32_16x16x32_bf16 v[20:23], v[192:195], v[180:183], v[20:23]
    ds_read_b128 v[36:39], v6 offset:0
    ds_read_b128 v[40:43], v6 offset:2048
    v_mfma_f32_16x16x32_bf16 v[24:27], v[192:195], v[184:187], v[24:27]
    ds_read_b64_tr_b16 v[44:45], v9 offset:0
    ds_read_b64_tr_b16 v[46:47], v9 offset:512
    v_mfma_f32_16x16x32_bf16 v[28:31], v[180:183], v[196:199], v[28:31]
    ds_read_b64_tr_b16 v[48:49], v9 offset:8192
    ds_read_b64_tr_b16 v[50:51], v9 offset:8704
    v_mfma_f32_16x16x32_bf16 v[32:35], v[184:187], v[196:199], v[32:35]
    ds_read_b64_tr_b16 v[52:53], v9 offset:16384
    ds_read_b64_tr_b16 v[54:55], v9 offset:16896
    v_mfma_f32_16x16x32_bf16 v[12:15], v[188:191], v[180:183], v[12:15]
    ds_read_b128 v[56:59], v7 offset:0
    ds_read_b128 v[60:63], v7 offset:2048
    v_mfma_f32_16x16x32_bf16 v[16:19], v[188:191], v[184:187], v[16:19]
    ds_read_b64_tr_b16 v[64:65], v9 offset:4096
    ds_read_b64_tr_b16 v[66:67], v9 offset:4608
    v_mfma_f32_16x16x32_bf16 v[20:23], v[212:215], v[200:203], v[20:23]
    ds_read_b64_tr_b16 v[68:69], v9 offset:12288
    ds_read_b64_tr_b16 v[70:71], v9 offset:12800
    v_mfma_f32_16x16x32_bf16 v[24:27], v[212:215], v[204:207], v[24:27]
    ds_read_b64_tr_b16 v[72:73], v9 offset:20480
    ds_read_b64_tr_b16 v[74:75], v9 offset:20992
    v_mfma_f32_16x16x32_bf16 v[28:31], v[200:203], v[216:219], v[28:31]
    s_add_u32 m0, s53, 0
    s_add_u32 s54, s31, 4
    s_and_b32 s54, s54, 7
    s_mul_i32 s54, s54, s52
    s_add_u32 s54, s54, s50
    buffer_load_dwordx4 v76, s[12:15], s54 offen lds
    v_mfma_f32_16x16x32_bf16 v[32:35], v[204:207], v[216:219], v[32:35]
    s_add_u32 m0, m0, 1024
    s_add_u32 s54, s54, s51
    buffer_load_dwordx4 v77, s[12:15], s54 offen lds
    v_mfma_f32_16x16x32_bf16 v[12:15], v[208:211], v[200:203], v[12:15]
    s_add_u32 m0, m0, 1024
    s_add_u32 s54, s54, s51
    buffer_load_dwordx4 v76, s[12:15], s54 offen lds
    v_mfma_f32_16x16x32_bf16 v[16:19], v[208:211], v[204:207], v[16:19]
    s_add_u32 m0, m0, 1024
    s_add_u32 s54, s54, s51
    buffer_load_dwordx4 v77, s[12:15], s54 offen lds
    s_waitcnt vmcnt(4) lgkmcnt(0)
    s_barrier
    v_mfma_f32_16x16x32_bf16 v[20:23], v[48:51], v[36:39], v[20:23]
    ds_read_b128 v[180:183], v6 offset:32768
    ds_read_b128 v[184:187], v6 offset:34816
    v_mfma_f32_16x16x32_bf16 v[24:27], v[48:51], v[40:43], v[24:27]
    ds_read_b64_tr_b16 v[188:189], v9 offset:32768
    ds_read_b64_tr_b16 v[190:191], v9 offset:33280
    v_mfma_f32_16x16x32_bf16 v[28:31], v[36:39], v[52:55], v[28:31]
    ds_read_b64_tr_b16 v[192:193], v9 offset:40960
    ds_read_b64_tr_b16 v[194:195], v9 offset:41472
    v_mfma_f32_16x16x32_bf16 v[32:35], v[40:43], v[52:55], v[32:35]
    ds_read_b64_tr_b16 v[196:197], v9 offset:49152
    ds_read_b64_tr_b16 v[198:199], v9 offset:49664
    v_mfma_f32_16x16x32_bf16 v[12:15], v[44:47], v[36:39], v[12:15]
    ds_read_b128 v[200:203], v7 offset:32768
    ds_read_b128 v[204:207], v7 offset:34816
    v_mfma_f32_16x16x32_bf16 v[16:19], v[44:47], v[40:43], v[16:19]
    ds_read_b64_tr_b16 v[208:209], v9 offset:36864
    ds_read_b64_tr_b16 v[210:211], v9 offset:37376
    v_mfma_f32_16x16x32_bf16 v[20:23], v[68:71], v[56:59], v[20:23]
    ds_read_b64_tr_b16 v[212:213], v9 offset:45056
    ds_read_b64_tr_b16 v[214:215], v9 offset:45568
    v_mfma_f32_16x16x32_bf16 v[24:27], v[68:71], v[60:63], v[24:27]
    ds_read_b64_tr_b16 v[216:217], v9 offset:53248
    ds_read_b64_tr_b16 v[218:219], v9 offset:53760
    v_mfma_f32_16x16x32_bf16 v[28:31], v[56:59], v[72:75], v[28:31]
    s_add_u32 m0, s53, 32768
    s_add_u32 s54, s31, 5
    s_and_b32 s54, s54, 7
    s_mul_i32 s54, s54, s52
    s_add_u32 s54, s54, s50
    buffer_load_dwordx4 v76, s[12:15], s54 offen lds
    v_mfma_f32_16x16x32_bf16 v[32:35], v[60:63], v[72:75], v[32:35]
    s_add_u32 m0, m0, 1024
    s_add_u32 s54, s54, s51
    buffer_load_dwordx4 v77, s[12:15], s54 offen lds
    v_mfma_f32_16x16x32_bf16 v[12:15], v[64:67], v[56:59], v[12:15]
    s_add_u32 m0, m0, 1024
    s_add_u32 s54, s54, s51
    buffer_load_dwordx4 v76, s[12:15], s54 offen lds
    v_mfma_f32_16x16x32_bf16 v[16:19], v[64:67], v[60:63], v[16:19]
    s_add_u32 m0, m0, 1024
    s_add_u32 s54, s54, s51
    buffer_load_dwordx4 v77, s[12:15], s54 offen lds
    s_waitcnt vmcnt(4) lgkmcnt(0)
    s_barrier
    v_mfma_f32_16x16x32_bf16 v[20:23], v[192:195], v[180:183], v[20:23]
    ds_read_b128 v[36:39], v4 offset:0
    ds_read_b128 v[40:43], v4 offset:2048
    v_mfma_f32_16x16x32_bf16 v[24:27], v[192:195], v[184:187], v[24:27]
    ds_read_b64_tr_b16 v[44:45], v8 offset:0
    ds_read_b64_tr_b16 v[46:47], v8 offset:512
    v_mfma_f32_16x16x32_bf16 v[28:31], v[180:183], v[196:199], v[28:31]
    ds_read_b64_tr_b16 v[48:49], v8 offset:8192
    ds_read_b64_tr_b16 v[50:51], v8 offset:8704
    v_mfma_f32_16x16x32_bf16 v[32:35], v[184:187], v[196:199], v[32:35]
    ds_read_b64_tr_b16 v[52:53], v8 offset:16384
    ds_read_b64_tr_b16 v[54:55], v8 offset:16896
    v_mfma_f32_16x16x32_bf16 v[12:15], v[188:191], v[180:183], v[12:15]
    ds_read_b128 v[56:59], v5 offset:0
    ds_read_b128 v[60:63], v5 offset:2048
    v_mfma_f32_16x16x32_bf16 v[16:19], v[188:191], v[184:187], v[16:19]
    ds_read_b64_tr_b16 v[64:65], v8 offset:4096
    ds_read_b64_tr_b16 v[66:67], v8 offset:4608
    v_mfma_f32_16x16x32_bf16 v[20:23], v[212:215], v[200:203], v[20:23]
    ds_read_b64_tr_b16 v[68:69], v8 offset:12288
    ds_read_b64_tr_b16 v[70:71], v8 offset:12800
    v_mfma_f32_16x16x32_bf16 v[24:27], v[212:215], v[204:207], v[24:27]
    ds_read_b64_tr_b16 v[72:73], v8 offset:20480
    ds_read_b64_tr_b16 v[74:75], v8 offset:20992
    v_mfma_f32_16x16x32_bf16 v[28:31], v[200:203], v[216:219], v[28:31]
    s_add_u32 m0, s53, 65536
    s_add_u32 s54, s31, 6
    s_and_b32 s54, s54, 7
    s_mul_i32 s54, s54, s52
    s_add_u32 s54, s54, s50
    buffer_load_dwordx4 v76, s[12:15], s54 offen lds
    v_mfma_f32_16x16x32_bf16 v[32:35], v[204:207], v[216:219], v[32:35]
    s_add_u32 m0, m0, 1024
    s_add_u32 s54, s54, s51
    buffer_load_dwordx4 v77, s[12:15], s54 offen lds
    v_mfma_f32_16x16x32_bf16 v[12:15], v[208:211], v[200:203], v[12:15]
    s_add_u32 m0, m0, 1024
    s_add_u32 s54, s54, s51
    buffer_load_dwordx4 v76, s[12:15], s54 offen lds
    v_mfma_f32_16x16x32_bf16 v[16:19], v[208:211], v[204:207], v[16:19]
    s_add_u32 m0, m0, 1024
    s_add_u32 s54, s54, s51
    buffer_load_dwordx4 v77, s[12:15], s54 offen lds
    s_waitcnt vmcnt(4) lgkmcnt(0)
    s_barrier
    v_mfma_f32_16x16x32_bf16 v[20:23], v[48:51], v[36:39], v[20:23]
    ds_read_b128 v[180:183], v4 offset:32768
    ds_read_b128 v[184:187], v4 offset:34816
    v_mfma_f32_16x16x32_bf16 v[24:27], v[48:51], v[40:43], v[24:27]
    ds_read_b64_tr_b16 v[188:189], v8 offset:32768
    ds_read_b64_tr_b16 v[190:191], v8 offset:33280
    v_mfma_f32_16x16x32_bf16 v[28:31], v[36:39], v[52:55], v[28:31]
    ds_read_b64_tr_b16 v[192:193], v8 offset:40960
    ds_read_b64_tr_b16 v[194:195], v8 offset:41472
    v_mfma_f32_16x16x32_bf16 v[32:35], v[40:43], v[52:55], v[32:35]
    ds_read_b64_tr_b16 v[196:197], v8 offset:49152
    ds_read_b64_tr_b16 v[198:199], v8 offset:49664
    v_mfma_f32_16x16x32_bf16 v[12:15], v[44:47], v[36:39], v[12:15]
    ds_read_b128 v[200:203], v5 offset:32768
    ds_read_b128 v[204:207], v5 offset:34816
    v_mfma_f32_16x16x32_bf16 v[16:19], v[44:47], v[40:43], v[16:19]
    ds_read_b64_tr_b16 v[208:209], v8 offset:36864
    ds_read_b64_tr_b16 v[210:211], v8 offset:37376
    v_mfma_f32_16x16x32_bf16 v[20:23], v[68:71], v[56:59], v[20:23]
    ds_read_b64_tr_b16 v[212:213], v8 offset:45056
    ds_read_b64_tr_b16 v[214:215], v8 offset:45568
    v_mfma_f32_16x16x32_bf16 v[24:27], v[68:71], v[60:63], v[24:27]
    ds_read_b64_tr_b16 v[216:217], v8 offset:53248
    ds_read_b64_tr_b16 v[218:219], v8 offset:53760
    v_mfma_f32_16x16x32_bf16 v[28:31], v[56:59], v[72:75], v[28:31]
    s_add_u32 m0, s53, 98304
    s_add_u32 s54, s31, 7
    s_and_b32 s54, s54, 7
    s_mul_i32 s54, s54, s52
    s_add_u32 s54, s54, s50
    buffer_load_dwordx4 v76, s[12:15], s54 offen lds
    v_mfma_f32_16x16x32_bf16 v[32:35], v[60:63], v[72:75], v[32:35]
    s_add_u32 m0, m0, 1024
    s_add_u32 s54, s54, s51
    buffer_load_dwordx4 v77, s[12:15], s54 offen lds
    v_mfma_f32_16x16x32_bf16 v[12:15], v[64:67], v[56:59], v[12:15]
    s_add_u32 m0, m0, 1024
    s_add_u32 s54, s54, s51
    buffer_load_dwordx4 v76, s[12:15], s54 offen lds
    v_mfma_f32_16x16x32_bf16 v[16:19], v[64:67], v[60:63], v[16:19]
    s_add_u32 m0, m0, 1024
    s_add_u32 s54, s54, s51
    buffer_load_dwordx4 v77, s[12:15], s54 offen lds
    s_waitcnt vmcnt(4) lgkmcnt(0)
    s_barrier
    v_mfma_f32_16x16x32_bf16 v[20:23], v[192:195], v[180:183], v[20:23]
    ds_read_b128 v[36:39], v6 offset:0
    ds_read_b128 v[40:43], v6 offset:2048
    v_mfma_f32_16x16x32_bf16 v[24:27], v[192:195], v[184:187], v[24:27]
    ds_read_b64_tr_b16 v[44:45], v9 offset:0
    ds_read_b64_tr_b16 v[46:47], v9 offset:512
    v_mfma_f32_16x16x32_bf16 v[28:31], v[180:183], v[196:199], v[28:31]
    ds_read_b64_tr_b16 v[48:49], v9 offset:8192
    ds_read_b64_tr_b16 v[50:51], v9 offset:8704
    v_mfma_f32_16x16x32_bf16 v[32:35], v[184:187], v[196:199], v[32:35]
    ds_read_b64_tr_b16 v[52:53], v9 offset:16384
    ds_read_b64_tr_b16 v[54:55], v9 offset:16896
    v_mfma_f32_16x16x32_bf16 v[12:15], v[188:191], v[180:183], v[12:15]
    ds_read_b128 v[56:59], v7 offset:0
    ds_read_b128 v[60:63], v7 offset:2048
    v_mfma_f32_16x16x32_bf16 v[16:19], v[188:191], v[184:187], v[16:19]
    ds_read_b64_tr_b16 v[64:65], v9 offset:4096
    ds_read_b64_tr_b16 v[66:67], v9 offset:4608
    v_mfma_f32_16x16x32_bf16 v[20:23], v[212:215], v[200:203], v[20:23]
    ds_read_b64_tr_b16 v[68:69], v9 offset:12288
    ds_read_b64_tr_b16 v[70:71], v9 offset:12800
    v_mfma_f32_16x16x32_bf16 v[24:27], v[212:215], v[204:207], v[24:27]
    ds_read_b64_tr_b16 v[72:73], v9 offset:20480
    ds_read_b64_tr_b16 v[74:75], v9 offset:20992
    v_mfma_f32_16x16x32_bf16 v[28:31], v[200:203], v[216:219], v[28:31]
    v_mfma_f32_16x16x32_bf16 v[32:35], v[204:207], v[216:219], v[32:35]
    v_mfma_f32_16x16x32_bf16 v[12:15], v[208:211], v[200:203], v[12:15]
    v_mfma_f32_16x16x32_bf16 v[16:19], v[208:211], v[204:207], v[16:19]
    s_waitcnt vmcnt(0) lgkmcnt(0)
    s_barrier
    v_mfma_f32_16x16x32_bf16 v[20:23], v[48:51], v[36:39], v[20:23]
    ds_read_b128 v[180:183], v6 offset:32768
    ds_read_b128 v[184:187], v6 offset:34816
    v_mfma_f32_16x16x32_bf16 v[24:27], v[48:51], v[40:43], v[24:27]
    ds_read_b64_tr_b16 v[188:189], v9 offset:32768
    ds_read_b64_tr_b16 v[190:191], v9 offset:33280
    v_mfma_f32_16x16x32_bf16 v[28:31], v[36:39], v[52:55], v[28:31]
    ds_read_b64_tr_b16 v[192:193], v9 offset:40960
    ds_read_b64_tr_b16 v[194:195], v9 offset:41472
    v_mfma_f32_16x16x32_bf16 v[32:35], v[40:43], v[52:55], v[32:35]
    ds_read_b64_tr_b16 v[196:197], v9 offset:49152
    ds_read_b64_tr_b16 v[198:199], v9 offset:49664
    v_mfma_f32_16x16x32_bf16 v[12:15], v[44:47], v[36:39], v[12:15]
    ds_read_b128 v[200:203], v7 offset:32768
    ds_read_b128 v[204:207], v7 offset:34816
    v_mfma_f32_16x16x32_bf16 v[16:19], v[44:47], v[40:43], v[16:19]
    ds_read_b64_tr_b16 v[208:209], v9 offset:36864
    ds_read_b64_tr_b16 v[210:211], v9 offset:37376
    v_mfma_f32_16x16x32_bf16 v[20:23], v[68:71], v[56:59], v[20:23]
    ds_read_b64_tr_b16 v[212:213], v9 offset:45056
    ds_read_b64_tr_b16 v[214:215], v9 offset:45568
    v_mfma_f32_16x16x32_bf16 v[24:27], v[68:71], v[60:63], v[24:27]
    ds_read_b64_tr_b16 v[216:217], v9 offset:53248
    ds_read_b64_tr_b16 v[218:219], v9 offset:53760
    v_mfma_f32_16x16x32_bf16 v[28:31], v[56:59], v[72:75], v[28:31]
    v_mfma_f32_16x16x32_bf16 v[32:35], v[60:63], v[72:75], v[32:35]
    v_mfma_f32_16x16x32_bf16 v[12:15], v[64:67], v[56:59], v[12:15]
    v_mfma_f32_16x16x32_bf16 v[16:19], v[64:67], v[60:63], v[16:19]
    s_waitcnt lgkmcnt(0)
    v_mfma_f32_16x16x32_bf16 v[20:23], v[192:195], v[180:183], v[20:23]
    v_mfma_f32_16x16x32_bf16 v[24:27], v[192:195], v[184:187], v[24:27]
    v_mfma_f32_16x16x32_bf16 v[28:31], v[180:183], v[196:199], v[28:31]
    v_mfma_f32_16x16x32_bf16 v[32:35], v[184:187], v[196:199], v[32:35]
    v_mfma_f32_16x16x32_bf16 v[12:15], v[188:191], v[180:183], v[12:15]
    v_mfma_f32_16x16x32_bf16 v[16:19], v[188:191], v[184:187], v[16:19]
    v_mfma_f32_16x16x32_bf16 v[20:23], v[212:215], v[200:203], v[20:23]
    v_mfma_f32_16x16x32_bf16 v[24:27], v[212:215], v[204:207], v[24:27]
    v_mfma_f32_16x16x32_bf16 v[28:31], v[200:203], v[216:219], v[28:31]
    v_mfma_f32_16x16x32_bf16 v[32:35], v[204:207], v[216:219], v[32:35]
    v_mfma_f32_16x16x32_bf16 v[12:15], v[208:211], v[200:203], v[12:15]
    v_mfma_f32_16x16x32_bf16 v[16:19], v[208:211], v[204:207], v[16:19]
    s_lshl_b32 s49, s27, 2
    s_add_u32 s49, s49, s48
    s_lshl_b32 s52, s49, 12
    s_lshl_b32 s49, s49, 6
    s_lshl_b32 s50, s26, 1
    s_add_u32 s50, s50, s30
    s_add_u32 s49, s49, s50
    s_lshl_b32 s53, s50, 3
    s_add_u32 s52, s52, s53
    s_add_u32 s52, s52, 0xc20000
    s_lshl_b32 s50, s49, 11
    s_lshl_b32 s49, s49, 10
    s_add_u32 s50, s50, 0x200000
    s_mov_b32 s51, 0x3eb8aa3b
    v_cvt_pk_bf16_f32 v40, v20, v21
    v_cvt_pk_bf16_f32 v41, v22, v23
    v_cvt_pk_bf16_f32 v42, v24, v25
    v_cvt_pk_bf16_f32 v43, v26, v27
    v_cvt_pk_bf16_f32 v44, v28, v29
    v_cvt_pk_bf16_f32 v45, v30, v31
    v_cvt_pk_bf16_f32 v46, v32, v33
    v_cvt_pk_bf16_f32 v47, v34, v35
    v_permlane16_swap_b32 v40, v42
    v_permlane16_swap_b32 v41, v43
    v_mul_f32 v12, s51, v12
    v_mul_f32 v13, s51, v13
    v_mul_f32 v14, s51, v14
    v_mul_f32 v15, s51, v15
    buffer_store_dwordx4 v[40:43], v1, s[20:23], s50 offen sc1
    v_permlane16_swap_b32 v44, v46
    v_permlane16_swap_b32 v45, v47
    v_mul_f32 v16, s51, v16
    v_mul_f32 v17, s51, v17
    v_mul_f32 v18, s51, v18
    v_mul_f32 v19, s51, v19
    buffer_store_dwordx4 v[44:47], v1, s[20:23], s50 offen offset:1024 sc1
    v_cvt_pk_bf16_f32 v36, v12, v13
    v_cvt_pk_bf16_f32 v37, v14, v15
    v_cvt_pk_bf16_f32 v38, v16, v17
    v_cvt_pk_bf16_f32 v39, v18, v19
    s_nop 1
    v_permlane16_swap_b32 v36, v38
    v_permlane16_swap_b32 v37, v39
    s_nop 1
    buffer_store_dwordx4 v[36:39], v1, s[20:23], s49 offen sc1
    s_load_dwordx4 s[4:7], s[0:1], 16
    s_load_dwordx4 s[8:11], s[0:1], 88
    v_lshlrev_b32 v4, 9, v0
    v_mov_b32 v6, s100
    v_mov_b32 v7, s101
    s_lshl_b32 s26, s24, 2
    s_and_b32 s27, s25, 3
    s_add_u32 s26, s26, s27
    s_lshr_b32 s27, s25, 2
    s_lshl_b32 s37, s26, 17
    s_add_u32 s37, s37, 0x200000
    s_lshl_b32 s36, s26, 3
    s_add_u32 s36, s36, s27
    s_lshl_b32 s36, s36, 9
    s_add_u32 s36, s36, 0xc20000
    s_cmp_ge_u32 s3, 4
    s_cbranch_scc1 P2_AUX
    s_mov_b64 exec, 0xff
    s_waitcnt vmcnt(0)
    buffer_store_dwordx2 v[6:7], v4, s[20:23], s52 offen sc1
    s_mov_b64 exec, -1
    s_lshl_b32 s35, s26, 6
    s_lshl_b32 s31, s27, 3
    s_add_u32 s35, s35, s31
    s_lshl_b32 s31, s3, 1
    s_add_u32 s35, s35, s31
    s_lshl_b32 s35, s35, 10
    s_lshl_b32 s31, s3, 11
    s_lshl_b32 s30, s27, 14
    s_add_u32 s30, s30, s31
    s_lshl_b32 s38, s27, 6
    s_add_u32 s36, s36, s38
    s_mov_b32 s40, 0xffff
    s_mov_b32 s41, 0xffff
    s_mov_b32 s42, 0x110000
    s_mov_b32 s43, 0x110000
    s_mov_b32 s34, 0
    v_mov_b32 v132, 0xdddd
    s_mov_b64 exec, s[42:43]
    v_mov_b32 v116, 0x3f803f80
    v_mov_b32 v117, 0x3f803f80
    v_mov_b32 v118, 0x3f803f80
    v_mov_b32 v119, 0x3f803f80
    v_mov_b32 v120, 0x3f803f80
    v_mov_b32 v121, 0x3f803f80
    v_mov_b32 v122, 0x3f803f80
    v_mov_b32 v123, 0x3f803f80
    v_mov_b32 v124, 0x3f803f80
    v_mov_b32 v125, 0x3f803f80
    v_mov_b32 v126, 0x3f803f80
    v_mov_b32 v127, 0x3f803f80
    v_mov_b32 v128, 0x3f803f80
    v_mov_b32 v129, 0x3f803f80
    v_mov_b32 v130, 0x3f803f80
    v_mov_b32 v131, 0x3f803f80
    s_not_b64 exec, exec
    v_mov_b32 v116, 0
    v_mov_b32 v117, 0
    v_mov_b32 v118, 0
    v_mov_b32 v119, 0
    v_mov_b32 v120, 0
    v_mov_b32 v121, 0
    v_mov_b32 v122, 0
    v_mov_b32 v123, 0
    v_mov_b32 v124, 0
    v_mov_b32 v125, 0
    v_mov_b32 v126, 0
    v_mov_b32 v127, 0
    v_mov_b32 v128, 0
    v_mov_b32 v129, 0
    v_mov_b32 v130, 0
    v_mov_b32 v131, 0
    s_mov_b64 exec, -1
    v_mov_b32 v44, 0
    v_mov_b32 v45, 0
    v_mov_b32 v46, 0
    v_mov_b32 v47, 0
    v_mov_b32 v48, 0
    v_mov_b32 v49, 0
    v_mov_b32 v50, 0
    v_mov_b32 v51, 0
    v_mov_b32 v52, 0
    v_mov_b32 v53, 0
    v_mov_b32 v54, 0
    v_mov_b32 v55, 0
    v_mov_b32 v56, 0
    v_mov_b32 v57, 0
    v_mov_b32 v58, 0
    v_mov_b32 v59, 0
    v_mov_b32 v60, 0
    v_mov_b32 v61, 0
    v_mov_b32 v62, 0
    v_mov_b32 v63, 0
    v_mov_b32 v64, 0
    v_mov_b32 v65, 0
    v_mov_b32 v66, 0
    v_mov_b32 v67, 0
    v_mov_b32 v68, 0
    v_mov_b32 v69, 0
    v_mov_b32 v70, 0
    v_mov_b32 v71, 0
    v_mov_b32 v72, 0
    v_mov_b32 v73, 0
    v_mov_b32 v74, 0
    v_mov_b32 v75, 0
    s_mov_b32 m0, s31
    v_lshlrev_b32 v2, 3, v0
    s_mov_b64 exec, 0xff
    s_mov_b32 s39, 0
P2_POLL:
    s_sleep 2
    buffer_load_dwordx2 v[140:141], v2, s[20:23], s36 offen sc1
    s_waitcnt vmcnt(0)
P2_POLL_C:
    v_cmp_ne_u64 vcc, v[140:141], v[6:7]
    s_add_u32 s39, s39, 1
    s_cmp_ge_u32 s39, 400000
    s_cbranch_scc1 P2_POLL_D
    s_cbranch_vccnz P2_POLL
P2_POLL_D:
    s_mov_b64 exec, -1
    s_add_u32 s38, s30, s37
    buffer_load_dwordx4 v1, s[20:23], s38 offen sc1 lds
    s_add_u32 m0, m0, 1024
    s_add_u32 s30, s30, 1024
    s_and_b32 s30, s30, 0x1ffff
    buffer_load_dwordx4 v[4:7], v1, s[20:23], s35 offen sc1
    buffer_load_dwordx4 v[8:11], v1, s[20:23], s35 offen offset:1024 sc1
    s_add_u32 s38, s30, s37
    buffer_load_dwordx4 v1, s[20:23], s38 offen sc1 lds
    s_add_u32 m0, m0, 7168
    s_add_u32 s30, s30, 7168
    s_and_b32 s30, s30, 0x1ffff
    s_add_u32 s38, s30, s37
    buffer_load_dwordx4 v1, s[20:23], s38 offen sc1 lds
    s_add_u32 m0, m0, 1024
    s_add_u32 s30, s30, 1024
    s_and_b32 s30, s30, 0x1ffff
    s_add_u32 s38, s30, s37
    buffer_load_dwordx4 v1, s[20:23], s38 offen sc1 lds
    s_add_u32 m0, m0, 1024
    s_add_u32 s30, s30, 1024
    s_and_b32 s30, s30, 0x1ffff
    v_add_u32 v2, s31, v1
    s_waitcnt vmcnt(3)
    ds_read_b128 v[108:111], v2
    s_waitcnt lgkmcnt(0)
    v_mfma_f32_32x32x16_bf16 v[76:91], v[108:111], v[4:7], 0
    v_mfma_f32_32x32x16_bf16 v[92:107], v[108:111], v[8:11], 0
    s_nop 10
    v_max3_f32 v3, v76, v77, v78
    v_max3_f32 v3, v3, v79, v80
    v_max3_f32 v3, v3, v81, v82
    v_max3_f32 v3, v3, v83, v84
    v_max3_f32 v3, v3, v85, v86
    v_max3_f32 v3, v3, v87, v88
    v_max3_f32 v3, v3, v89, v90
    v_max_f32 v3, v3, v91
    v_max3_f32 v133, v92, v93, v94
    v_max3_f32 v133, v133, v95, v96
    v_max3_f32 v133, v133, v97, v98
    v_max3_f32 v133, v133, v99, v100
    v_max3_f32 v133, v133, v101, v102
    v_max3_f32 v133, v133, v103, v104
    v_max3_f32 v133, v133, v105, v106
    v_max_f32 v133, v133, v107
K2_PASS:
    v_mov_b32 v2, v3
    v_mov_b32 v134, v133
    s_nop 1
    v_permlane32_swap_b32 v3, v2
    v_permlane32_swap_b32 v133, v134
    s_nop 1
    v_max_f32 v3, v3, v2
    v_max_f32 v133, v133, v134
    v_mov_b32 v2, v1
    v_sub_f32 v12, 0, v3
    v_sub_f32 v13, 0, v3
    v_sub_f32 v14, 0, v3
    v_sub_f32 v15, 0, v3
    v_sub_f32 v16, 0, v3
    v_sub_f32 v17, 0, v3
    v_sub_f32 v18, 0, v3
    v_sub_f32 v19, 0, v3
    v_sub_f32 v20, 0, v3
    v_sub_f32 v21, 0, v3
    v_sub_f32 v22, 0, v3
    v_sub_f32 v23, 0, v3
    v_sub_f32 v24, 0, v3
    v_sub_f32 v25, 0, v3
    v_sub_f32 v26, 0, v3
    v_sub_f32 v27, 0, v3
    v_sub_f32 v28, 0, v133
    v_sub_f32 v29, 0, v133
    v_sub_f32 v30, 0, v133
    v_sub_f32 v31, 0, v133
    v_sub_f32 v32, 0, v133
    v_sub_f32 v33, 0, v133
    v_sub_f32 v34, 0, v133
    v_sub_f32 v35, 0, v133
    v_sub_f32 v36, 0, v133
    v_sub_f32 v37, 0, v133
    v_sub_f32 v38, 0, v133
    v_sub_f32 v39, 0, v133
    v_sub_f32 v40, 0, v133
    v_sub_f32 v41, 0, v133
    v_sub_f32 v42, 0, v133
    v_sub_f32 v43, 0, v133
    v_mov_b32 v100, 0
    v_mov_b32 v101, 0
    v_mov_b32 v102, 0
    v_mov_b32 v103, 0
    v_mov_b32 v104, 0
    v_mov_b32 v105, 0
    v_mov_b32 v106, 0
    v_mov_b32 v107, 0
    s_mov_b32 s32, 0
    s_mov_b32 s33, 16
    s_cmp_lg_u32 s34, 0
    s_cbranch_scc1 K2_GO
    s_mov_b32 s33, 1
    s_waitcnt vmcnt(0)
    s_barrier
K2_GO:
    ds_read_b128 v[108:111], v1
    ds_read_b128 v[112:115], v1 offset:2048
    s_mov_b64 exec, s[40:41]
    ds_read_b128 v[116:119], v1 offset:1024
    ds_read_b128 v[124:127], v1 offset:1280
    s_mov_b64 exec, -1
    s_waitcnt lgkmcnt(3)
    v_mfma_f32_32x32x16_bf16 v[76:91], v[108:111], v[4:7], v[12:27]
    s_nop 11
.p2align 6
K2_LOOP:
    v_exp_f32 v76, v76
    v_exp_f32 v77, v77
    s_waitcnt lgkmcnt(0)
    v_smfmac_f32_32x32x32_bf16 v[60:75], v[128:131], v[100:107], v132
    s_mov_b64 exec, s[40:41]
    ds_read_b128 v[120:123], v2 offset:3072
    ds_read_b128 v[128:131], v2 offset:3328
    s_mov_b64 exec, -1
    v_exp_f32 v78, v78
    v_exp_f32 v79, v79
    v_exp_f32 v80, v80
    v_mfma_f32_32x32x16_bf16 v[92:107], v[108:111], v[8:11], v[28:43]
    ds_read_b128 v[108:111], v2 offset:4096
    v_exp_f32 v81, v81
    v_exp_f32 v82, v82
    v_exp_f32 v83, v83
    v_exp_f32 v84, v84
    v_exp_f32 v85, v85
    v_exp_f32 v86, v86
    v_smfmac_f32_32x32x32_bf16 v[44:59], v[116:119], v[76:83], v132
    v_exp_f32 v87, v87
    v_exp_f32 v88, v88
    v_exp_f32 v89, v89
    v_exp_f32 v90, v90
    v_exp_f32 v91, v91
    v_exp_f32 v92, v92
    v_exp_f32 v93, v93
    v_smfmac_f32_32x32x32_bf16 v[44:59], v[124:127], v[84:91], v132
    v_exp_f32 v94, v94
    v_exp_f32 v95, v95
    v_exp_f32 v96, v96
    v_mfma_f32_32x32x16_bf16 v[76:91], v[112:115], v[4:7], v[12:27]
    v_exp_f32 v97, v97
    v_exp_f32 v98, v98
    v_exp_f32 v99, v99
    v_exp_f32 v100, v100
    v_exp_f32 v101, v101
    v_exp_f32 v102, v102
    v_smfmac_f32_32x32x32_bf16 v[60:75], v[116:119], v[92:99], v132
    v_exp_f32 v103, v103
    v_exp_f32 v104, v104
    v_exp_f32 v105, v105
    v_exp_f32 v106, v106
    v_exp_f32 v107, v107
    v_exp_f32 v76, v76
    v_exp_f32 v77, v77
    s_waitcnt lgkmcnt(0)
    v_smfmac_f32_32x32x32_bf16 v[60:75], v[124:127], v[100:107], v132
    s_mov_b64 exec, s[40:41]
    ds_read_b128 v[116:119], v2 offset:5120
    ds_read_b128 v[124:127], v2 offset:5376
    s_mov_b64 exec, -1
    v_exp_f32 v78, v78
    v_exp_f32 v79, v79
    v_exp_f32 v80, v80
    v_mfma_f32_32x32x16_bf16 v[92:107], v[112:115], v[8:11], v[28:43]
    ds_read_b128 v[112:115], v2 offset:6144
    v_exp_f32 v81, v81
    v_exp_f32 v82, v82
    v_exp_f32 v83, v83
    v_exp_f32 v84, v84
    v_exp_f32 v85, v85
    v_exp_f32 v86, v86
    v_smfmac_f32_32x32x32_bf16 v[44:59], v[120:123], v[76:83], v132
    v_exp_f32 v87, v87
    v_exp_f32 v88, v88
    v_exp_f32 v89, v89
    v_exp_f32 v90, v90
    v_exp_f32 v91, v91
    v_exp_f32 v92, v92
    v_exp_f32 v93, v93
    v_smfmac_f32_32x32x32_bf16 v[44:59], v[128:131], v[84:91], v132
    v_exp_f32 v94, v94
    v_exp_f32 v95, v95
    v_exp_f32 v96, v96
    v_mfma_f32_32x32x16_bf16 v[76:91], v[108:111], v[4:7], v[12:27]
    v_exp_f32 v97, v97
    v_exp_f32 v98, v98
    v_exp_f32 v99, v99
    v_exp_f32 v100, v100
    v_exp_f32 v101, v101
    v_exp_f32 v102, v102
    v_smfmac_f32_32x32x32_bf16 v[60:75], v[120:123], v[92:99], v132
    v_exp_f32 v103, v103
    v_exp_f32 v104, v104
    v_exp_f32 v105, v105
    v_exp_f32 v106, v106
    v_exp_f32 v107, v107
    v_exp_f32 v76, v76
    v_exp_f32 v77, v77
    s_waitcnt lgkmcnt(0)
    v_smfmac_f32_32x32x32_bf16 v[60:75], v[128:131], v[100:107], v132
    s_mov_b64 exec, s[40:41]
    ds_read_b128 v[120:123], v2 offset:7168
    ds_read_b128 v[128:131], v2 offset:7424
    s_mov_b64 exec, -1
    v_exp_f32 v78, v78
    v_exp_f32 v79, v79
    v_exp_f32 v80, v80
    v_mfma_f32_32x32x16_bf16 v[92:107], v[108:111], v[8:11], v[28:43]
    ds_read_b128 v[108:111], v2 offset:8192
    v_exp_f32 v81, v81
    v_exp_f32 v82, v82
    v_exp_f32 v83, v83
    v_exp_f32 v84, v84
    v_exp_f32 v85, v85
    v_exp_f32 v86, v86
    v_smfmac_f32_32x32x32_bf16 v[44:59], v[116:119], v[76:83], v132
    v_exp_f32 v87, v87
    v_exp_f32 v88, v88
    v_exp_f32 v89, v89
    v_exp_f32 v90, v90
    v_exp_f32 v91, v91
    v_exp_f32 v92, v92
    v_exp_f32 v93, v93
    v_smfmac_f32_32x32x32_bf16 v[44:59], v[124:127], v[84:91], v132
    v_exp_f32 v94, v94
    v_exp_f32 v95, v95
    v_exp_f32 v96, v96
    v_mfma_f32_32x32x16_bf16 v[76:91], v[112:115], v[4:7], v[12:27]
    v_exp_f32 v97, v97
    v_exp_f32 v98, v98
    v_exp_f32 v99, v99
    v_exp_f32 v100, v100
    v_exp_f32 v101, v101
    v_exp_f32 v102, v102
    v_smfmac_f32_32x32x32_bf16 v[60:75], v[116:119], v[92:99], v132
    v_exp_f32 v103, v103
    v_exp_f32 v104, v104
    v_exp_f32 v105, v105
    v_exp_f32 v106, v106
    v_exp_f32 v107, v107
    v_exp_f32 v76, v76
    v_exp_f32 v77, v77
    s_waitcnt lgkmcnt(0)
    v_smfmac_f32_32x32x32_bf16 v[60:75], v[124:127], v[100:107], v132
    s_mov_b64 exec, s[40:41]
    ds_read_b128 v[116:119], v2 offset:9216
    ds_read_b128 v[124:127], v2 offset:9472
    s_mov_b64 exec, -1
    v_exp_f32 v78, v78
    v_exp_f32 v79, v79
    v_exp_f32 v80, v80
    v_mfma_f32_32x32x16_bf16 v[92:107], v[112:115], v[8:11], v[28:43]
    ds_read_b128 v[112:115], v2 offset:10240
    v_exp_f32 v81, v81
    v_exp_f32 v82, v82
    v_exp_f32 v83, v83
    v_exp_f32 v84, v84
    v_exp_f32 v85, v85
    v_exp_f32 v86, v86
    v_smfmac_f32_32x32x32_bf16 v[44:59], v[120:123], v[76:83], v132
    v_exp_f32 v87, v87
    v_exp_f32 v88, v88
    v_exp_f32 v89, v89
    v_exp_f32 v90, v90
    v_exp_f32 v91, v91
    v_add_u32 v2, 8192, v2
    s_add_u32 s32, s32, 1
    s_cmp_lt_u32 s32, s33
    v_exp_f32 v92, v92
    v_exp_f32 v93, v93
    v_smfmac_f32_32x32x32_bf16 v[44:59], v[128:131], v[84:91], v132
    v_exp_f32 v94, v94
    v_exp_f32 v95, v95
    v_exp_f32 v96, v96
    v_mfma_f32_32x32x16_bf16 v[76:91], v[108:111], v[4:7], v[12:27]
    v_exp_f32 v97, v97
    v_exp_f32 v98, v98
    v_exp_f32 v99, v99
    v_exp_f32 v100, v100
    v_exp_f32 v101, v101
    v_exp_f32 v102, v102
    v_smfmac_f32_32x32x32_bf16 v[60:75], v[120:123], v[92:99], v132
    v_exp_f32 v103, v103
    v_exp_f32 v104, v104
    v_exp_f32 v105, v105
    v_exp_f32 v106, v106
    v_exp_f32 v107, v107
    s_cbranch_scc1 K2_LOOP
    s_cmp_ge_u32 s32, 16
    s_cbranch_scc1 K2_FIN
    s_barrier
    s_cmp_eq_u32 s32, 5
    s_cselect_b32 s33, 6, 16
    s_cmp_eq_u32 s32, 1
    s_cselect_b32 s33, 5, s33
    s_branch K2_LOOP
K2_FIN:
    v_smfmac_f32_32x32x32_bf16 v[60:75], v[128:131], v[100:107], v132
    v_mul_f32 v3, 0, v52
    v_fma_f32 v3, v44, 0, v3
    v_fma_f32 v3, v45, 0, v3
    v_fma_f32 v3, v46, 0, v3
    v_fma_f32 v3, v47, 0, v3
    v_fma_f32 v3, v48, 0, v3
    v_fma_f32 v3, v49, 0, v3
    v_fma_f32 v3, v50, 0, v3
    v_fma_f32 v3, v51, 0, v3
    s_nop 3
    v_fma_f32 v3, v60, 0, v3
    v_fma_f32 v3, v61, 0, v3
    v_fma_f32 v3, v62, 0, v3
    v_fma_f32 v3, v63, 0, v3
    v_fma_f32 v3, v64, 0, v3
    v_fma_f32 v3, v65, 0, v3
    v_fma_f32 v3, v66, 0, v3
    v_fma_f32 v3, v67, 0, v3
    v_fma_f32 v3, v68, 0, v3
    s_cmp_lg_u32 s34, 0
    s_cbranch_scc1 K2_OUT
    v_cmp_u_f32 vcc, v3, v3
    s_nop 1
    s_cbranch_vccz K2_OUT
    s_mov_b32 s34, 1
    s_mov_b32 s32, 0
    v_mov_b32 v2, v1
    v_mov_b32 v3, 0xff800000
    v_mov_b32 v133, 0xff800000
    s_waitcnt lgkmcnt(0)
K2_MAXL:
    ds_read_b128 v[108:111], v2
    v_add_u32 v2, 2048, v2
    s_waitcnt lgkmcnt(0)
    v_mfma_f32_32x32x16_bf16 v[76:91], v[108:111], v[4:7], 0
    v_mfma_f32_32x32x16_bf16 v[92:107], v[108:111], v[8:11], 0
    s_nop 15
    v_max3_f32 v3, v3, v76, v77
    v_max3_f32 v3, v3, v78, v79
    v_max3_f32 v3, v3, v80, v81
    v_max3_f32 v3, v3, v82, v83
    v_max3_f32 v3, v3, v84, v85
    v_max3_f32 v3, v3, v86, v87
    v_max3_f32 v3, v3, v88, v89
    v_max3_f32 v3, v3, v90, v91
    v_max3_f32 v133, v133, v92, v93
    v_max3_f32 v133, v133, v94, v95
    v_max3_f32 v133, v133, v96, v97
    v_max3_f32 v133, v133, v98, v99
    v_max3_f32 v133, v133, v100, v101
    v_max3_f32 v133, v133, v102, v103
    v_max3_f32 v133, v133, v104, v105
    v_max3_f32 v133, v133, v106, v107
    s_add_u32 s32, s32, 1
    s_cmp_lt_u32 s32, 64
    s_cbranch_scc1 K2_MAXL
    s_mov_b64 exec, s[42:43]
    v_mov_b32 v116, 0x3f803f80
    v_mov_b32 v117, 0x3f803f80
    v_mov_b32 v118, 0x3f803f80
    v_mov_b32 v119, 0x3f803f80
    v_mov_b32 v120, 0x3f803f80
    v_mov_b32 v121, 0x3f803f80
    v_mov_b32 v122, 0x3f803f80
    v_mov_b32 v123, 0x3f803f80
    v_mov_b32 v124, 0x3f803f80
    v_mov_b32 v125, 0x3f803f80
    v_mov_b32 v126, 0x3f803f80
    v_mov_b32 v127, 0x3f803f80
    v_mov_b32 v128, 0x3f803f80
    v_mov_b32 v129, 0x3f803f80
    v_mov_b32 v130, 0x3f803f80
    v_mov_b32 v131, 0x3f803f80
    s_not_b64 exec, exec
    v_mov_b32 v116, 0
    v_mov_b32 v117, 0
    v_mov_b32 v118, 0
    v_mov_b32 v119, 0
    v_mov_b32 v120, 0
    v_mov_b32 v121, 0
    v_mov_b32 v122, 0
    v_mov_b32 v123, 0
    v_mov_b32 v124, 0
    v_mov_b32 v125, 0
    v_mov_b32 v126, 0
    v_mov_b32 v127, 0
    v_mov_b32 v128, 0
    v_mov_b32 v129, 0
    v_mov_b32 v130, 0
    v_mov_b32 v131, 0
    s_mov_b64 exec, -1
    v_mov_b32 v44, 0
    v_mov_b32 v45, 0
    v_mov_b32 v46, 0
    v_mov_b32 v47, 0
    v_mov_b32 v48, 0
    v_mov_b32 v49, 0
    v_mov_b32 v50, 0
    v_mov_b32 v51, 0
    v_mov_b32 v52, 0
    v_mov_b32 v53, 0
    v_mov_b32 v54, 0
    v_mov_b32 v55, 0
    v_mov_b32 v56, 0
    v_mov_b32 v57, 0
    v_mov_b32 v58, 0
    v_mov_b32 v59, 0
    v_mov_b32 v60, 0
    v_mov_b32 v61, 0
    v_mov_b32 v62, 0
    v_mov_b32 v63, 0
    v_mov_b32 v64, 0
    v_mov_b32 v65, 0
    v_mov_b32 v66, 0
    v_mov_b32 v67, 0
    v_mov_b32 v68, 0
    v_mov_b32 v69, 0
    v_mov_b32 v70, 0
    v_mov_b32 v71, 0
    v_mov_b32 v72, 0
    v_mov_b32 v73, 0
    v_mov_b32 v74, 0
    v_mov_b32 v75, 0
    s_branch K2_PASS
K2_OUT:
    v_rcp_f32 v3, v52
    v_rcp_f32 v133, v68
    s_lshl_b32 s30, s27, 3
    s_lshl_b32 s31, s3, 1
    s_add_u32 s30, s30, s31
    s_lshl_b32 s30, s30, 5
    s_add_u32 s30, s30, s26
    s_lshl_b32 s30, s30, 10
    s_add_u32 s30, s30, 0x600000
    s_add_u32 s31, s30, 32768
    v_mul_f32 v44, v44, v3
    v_mul_f32 v45, v45, v3
    v_mul_f32 v46, v46, v3
    v_mul_f32 v47, v47, v3
    v_mul_f32 v48, v48, v3
    v_mul_f32 v49, v49, v3
    v_mul_f32 v50, v50, v3
    v_mul_f32 v51, v51, v3
    v_cvt_pk_bf16_f32 v76, v44, v45
    v_cvt_pk_bf16_f32 v77, v46, v47
    v_cvt_pk_bf16_f32 v78, v48, v49
    v_cvt_pk_bf16_f32 v79, v50, v51
    buffer_store_dwordx4 v[76:79], v1, s[20:23], s30 offen sc1
    v_mul_f32 v60, v60, v133
    v_mul_f32 v61, v61, v133
    v_mul_f32 v62, v62, v133
    v_mul_f32 v63, v63, v133
    v_mul_f32 v64, v64, v133
    v_mul_f32 v65, v65, v133
    v_mul_f32 v66, v66, v133
    v_mul_f32 v67, v67, v133
    v_cvt_pk_bf16_f32 v80, v60, v61
    v_cvt_pk_bf16_f32 v81, v62, v63
    v_cvt_pk_bf16_f32 v82, v64, v65
    v_cvt_pk_bf16_f32 v83, v66, v67
    buffer_store_dwordx4 v[80:83], v1, s[20:23], s31 offen sc1
    s_mov_b32 s12, s4
    s_mov_b32 s13, s5
    s_mov_b32 s14, 0x80000
    s_mov_b32 s15, 0x00020000
    s_mov_b32 s16, s10
    s_mov_b32 s17, s11
    s_mov_b32 s18, 0x400000
    s_mov_b32 s19, 0x00020000
    s_and_b32 s30, s3, 1
    s_lshr_b32 s31, s3, 1
    s_lshl_b32 s32, s27, 2
    s_bfe_u32 s33, s26, 0x20002
    s_add_u32 s32, s32, s33
    s_lshl_b32 s32, s32, 1
    s_add_u32 s32, s32, s30
    s_lshr_b32 s35, s26, 4
    s_lshl_b32 s35, s35, 2
    s_and_b32 s34, s26, 3
    s_add_u32 s35, s35, s34
    s_lshl_b32 s34, s35, 1
    s_add_u32 s34, s34, s31
    s_lshl_b32 s42, s31, 14
    s_lshl_b32 s43, s32, 15
    s_add_u32 s42, s42, s43
    s_add_u32 s42, s42, 0x600000
    s_add_u32 s43, s42, 4096
    s_add_u32 s44, s42, 8192
    s_add_u32 s45, s42, 12288
    v_lshrrev_b32 v2, 3, v0
    v_and_b32 v3, 7, v0
    v_bfe_u32 v4, v0, 4, 1
    v_lshlrev_b32 v4, 2, v4
    v_xor_b32 v3, v3, v4
    v_lshlrev_b32 v3, 4, v3
    v_lshl_add_u32 v2, v2, 10, v3
    s_lshl_b32 s36, s3, 17
    s_lshl_b32 s37, s35, 7
    s_add_u32 s36, s36, s37
    s_lshl_b32 s37, s3, 14
    s_mov_b32 m0, s37
    v_lshrrev_b32 v3, 5, v0
    v_bfe_u32 v4, v0, 2, 2
    v_lshl_add_u32 v3, v3, 2, v4
    v_lshlrev_b32 v3, 7, v3
    v_bfe_u32 v4, v0, 3, 1
    v_xor_b32 v4, s31, v4
    v_lshl_add_u32 v3, v4, 6, v3
    v_bfe_u32 v4, v0, 4, 1
    v_lshl_add_u32 v3, v4, 5, v3
    v_and_b32 v4, 3, v0
    v_lshl_add_u32 v3, v4, 3, v3
    s_lshl_b32 s37, s31, 15
    v_add_u32 v250, s37, v3
    v_xor_b32 v251, 64, v250
    v_mov_b32 v252, s100
    v_mov_b32 v253, s101
    v_lshrrev_b32 v5, 2, v0
    v_lshlrev_b32 v5, 4, v5
    v_and_b32 v8, 3, v0
    v_add_u32 v5, v5, v8
    v_lshlrev_b32 v5, 8, v5
    s_lshl_b32 s38, s27, 13
    s_lshl_b32 s39, s26, 3
    s_add_u32 s38, s38, s39
    s_lshl_b32 s39, s3, 10
    s_add_u32 s38, s38, s39
    s_add_u32 s38, s38, 0xc00000
    v_mov_b32 v8, 160768
    v_mov_b32 v9, 1
    s_mov_b64 exec, 1
    s_waitcnt lgkmcnt(0)
    ds_add_u32 v8, v9 offset:0
    s_mov_b64 exec, 0xff
    s_waitcnt vmcnt(0)
    buffer_store_dwordx2 v[252:253], v5, s[20:23], s38 offen sc1
    s_mov_b64 exec, 1
    s_mov_b32 s39, 0
P3_S1:
    ds_read_b32 v9, v8 offset:0
    s_add_u32 s39, s39, 1
    s_waitcnt lgkmcnt(0)
    v_cmp_gt_u32 vcc, 4, v9
    s_cmp_ge_u32 s39, 3200000
    s_cbranch_scc1 P3_S1_D
    s_cbranch_vccz P3_S1_D
    s_sleep 0
    s_branch P3_S1
P3_S1_D:
    s_mov_b64 exec, -1
    buffer_load_dwordx4 v2, s[12:15], s36 offen lds
    s_add_u32 m0, m0, 1024
    s_add_u32 s36, s36, 8192
    buffer_load_dwordx4 v2, s[12:15], s36 offen lds
    s_add_u32 m0, m0, 1024
    s_add_u32 s36, s36, 8192
    buffer_load_dwordx4 v2, s[12:15], s36 offen lds
    s_add_u32 m0, m0, 1024
    s_add_u32 s36, s36, 8192
    buffer_load_dwordx4 v2, s[12:15], s36 offen lds
    s_add_u32 m0, m0, 1024
    s_add_u32 s36, s36, 8192
    buffer_load_dwordx4 v2, s[12:15], s36 offen lds
    s_add_u32 m0, m0, 1024
    s_add_u32 s36, s36, 8192
    buffer_load_dwordx4 v2, s[12:15], s36 offen lds
    s_add_u32 m0, m0, 1024
    s_add_u32 s36, s36, 8192
    buffer_load_dwordx4 v2, s[12:15], s36 offen lds
    s_add_u32 m0, m0, 1024
    s_add_u32 s36, s36, 8192
    buffer_load_dwordx4 v2, s[12:15], s36 offen lds
    s_add_u32 m0, m0, 1024
    s_add_u32 s36, s36, 8192
    buffer_load_dwordx4 v2, s[12:15], s36 offen lds
    s_add_u32 m0, m0, 1024
    s_add_u32 s36, s36, 8192
    buffer_load_dwordx4 v2, s[12:15], s36 offen lds
    s_add_u32 m0, m0, 1024
    s_add_u32 s36, s36, 8192
    buffer_load_dwordx4 v2, s[12:15], s36 offen lds
    s_add_u32 m0, m0, 1024
    s_add_u32 s36, s36, 8192
    buffer_load_dwordx4 v2, s[12:15], s36 offen lds
    s_add_u32 m0, m0, 1024
    s_add_u32 s36, s36, 8192
    buffer_load_dwordx4 v2, s[12:15], s36 offen lds
    s_add_u32 m0, m0, 1024
    s_add_u32 s36, s36, 8192
    buffer_load_dwordx4 v2, s[12:15], s36 offen lds
    s_add_u32 m0, m0, 1024
    s_add_u32 s36, s36, 8192
    buffer_load_dwordx4 v2, s[12:15], s36 offen lds
    s_add_u32 m0, m0, 1024
    s_add_u32 s36, s36, 8192
    buffer_load_dwordx4 v2, s[12:15], s36 offen lds
    s_lshl_b32 s38, s27, 5
    s_add_u32 s38, s38, s26
    s_lshl_b32 s38, s38, 8
    s_lshl_b32 s39, s31, 7
    s_add_u32 s38, s38, s39
    s_add_u32 s38, s38, 0xc00000
    v_lshlrev_b32 v5, 3, v0
    s_mov_b64 exec, 0xffff
    s_mov_b32 s39, 0
    buffer_load_dwordx2 v[232:233], v5, s[20:23], s38 offen sc1
    s_waitcnt vmcnt(0)
    v_mov_b32 v8, 160768
    v_mov_b32 v9, 1
    s_mov_b64 exec, 1
    s_waitcnt lgkmcnt(0)
    ds_add_u32 v8, v9 offset:4
    s_mov_b64 exec, 0xffff
    s_branch P3_POLL_C
P3_POLL:
    s_sleep 2
    buffer_load_dwordx2 v[232:233], v5, s[20:23], s38 offen sc1
    s_waitcnt vmcnt(0)
P3_POLL_C:
    v_cmp_ne_u64 vcc, v[232:233], v[252:253]
    s_add_u32 s39, s39, 1
    s_cmp_ge_u32 s39, 400000
    s_cbranch_scc1 P3_POLL_D
    s_cbranch_vccnz P3_POLL
P3_POLL_D:
    s_mov_b64 exec, -1
    buffer_load_dwordx4 v[164:167], v1, s[20:23], s42 offen offset:0 sc1
    buffer_load_dwordx4 v[168:171], v1, s[20:23], s42 offen offset:1024 sc1
    buffer_load_dwordx4 v[172:175], v1, s[20:23], s42 offen offset:2048 sc1
    buffer_load_dwordx4 v[176:179], v1, s[20:23], s42 offen offset:3072 sc1
    buffer_load_dwordx4 v[180:183], v1, s[20:23], s43 offen offset:0 sc1
    buffer_load_dwordx4 v[184:187], v1, s[20:23], s43 offen offset:1024 sc1
    buffer_load_dwordx4 v[188:191], v1, s[20:23], s43 offen offset:2048 sc1
    buffer_load_dwordx4 v[192:195], v1, s[20:23], s43 offen offset:3072 sc1
    buffer_load_dwordx4 v[196:199], v1, s[20:23], s44 offen offset:0 sc1
    buffer_load_dwordx4 v[200:203], v1, s[20:23], s44 offen offset:1024 sc1
    buffer_load_dwordx4 v[204:207], v1, s[20:23], s44 offen offset:2048 sc1
    buffer_load_dwordx4 v[208:211], v1, s[20:23], s44 offen offset:3072 sc1
    buffer_load_dwordx4 v[212:215], v1, s[20:23], s45 offen offset:0 sc1
    buffer_load_dwordx4 v[216:219], v1, s[20:23], s45 offen offset:1024 sc1
    buffer_load_dwordx4 v[220:223], v1, s[20:23], s45 offen offset:2048 sc1
    buffer_load_dwordx4 v[224:227], v1, s[20:23], s45 offen offset:3072 sc1
    s_mov_b64 exec, 1
    s_mov_b32 s39, 0
P3_S2:
    ds_read_b32 v9, v8 offset:4
    s_add_u32 s39, s39, 1
    s_waitcnt lgkmcnt(0)
    v_cmp_gt_u32 vcc, 4, v9
    s_cmp_ge_u32 s39, 3200000
    s_cbranch_scc1 P3_S2_D
    s_cbranch_vccz P3_S2_D
    s_sleep 0
    s_branch P3_S2
P3_S2_D:
    s_mov_b64 exec, -1
    ds_read_b64_tr_b16 v[36:37], v250 offset:0
    ds_read_b64_tr_b16 v[38:39], v250 offset:1024
    ds_read_b64_tr_b16 v[40:41], v251 offset:0
    ds_read_b64_tr_b16 v[42:43], v251 offset:1024
    ds_read_b64_tr_b16 v[44:45], v250 offset:2048
    ds_read_b64_tr_b16 v[46:47], v250 offset:3072
    ds_read_b64_tr_b16 v[48:49], v251 offset:2048
    ds_read_b64_tr_b16 v[50:51], v251 offset:3072
    ds_read_b64_tr_b16 v[52:53], v250 offset:4096
    ds_read_b64_tr_b16 v[54:55], v250 offset:5120
    ds_read_b64_tr_b16 v[56:57], v251 offset:4096
    ds_read_b64_tr_b16 v[58:59], v251 offset:5120
    ds_read_b64_tr_b16 v[60:61], v250 offset:6144
    ds_read_b64_tr_b16 v[62:63], v250 offset:7168
    ds_read_b64_tr_b16 v[64:65], v251 offset:6144
    ds_read_b64_tr_b16 v[66:67], v251 offset:7168
    ds_read_b64_tr_b16 v[68:69], v250 offset:8192
    ds_read_b64_tr_b16 v[70:71], v250 offset:9216
    ds_read_b64_tr_b16 v[72:73], v251 offset:8192
    ds_read_b64_tr_b16 v[74:75], v251 offset:9216
    ds_read_b64_tr_b16 v[76:77], v250 offset:10240
    ds_read_b64_tr_b16 v[78:79], v250 offset:11264
    ds_read_b64_tr_b16 v[80:81], v251 offset:10240
    ds_read_b64_tr_b16 v[82:83], v251 offset:11264
    ds_read_b64_tr_b16 v[84:85], v250 offset:12288
    ds_read_b64_tr_b16 v[86:87], v250 offset:13312
    ds_read_b64_tr_b16 v[88:89], v251 offset:12288
    ds_read_b64_tr_b16 v[90:91], v251 offset:13312
    ds_read_b64_tr_b16 v[92:93], v250 offset:14336
    ds_read_b64_tr_b16 v[94:95], v250 offset:15360
    ds_read_b64_tr_b16 v[96:97], v251 offset:14336
    ds_read_b64_tr_b16 v[98:99], v251 offset:15360
    ds_read_b64_tr_b16 v[100:101], v250 offset:16384
    ds_read_b64_tr_b16 v[102:103], v250 offset:17408
    ds_read_b64_tr_b16 v[104:105], v251 offset:16384
    ds_read_b64_tr_b16 v[106:107], v251 offset:17408
    ds_read_b64_tr_b16 v[108:109], v250 offset:18432
    ds_read_b64_tr_b16 v[110:111], v250 offset:19456
    ds_read_b64_tr_b16 v[112:113], v251 offset:18432
    ds_read_b64_tr_b16 v[114:115], v251 offset:19456
    ds_read_b64_tr_b16 v[116:117], v250 offset:20480
    ds_read_b64_tr_b16 v[118:119], v250 offset:21504
    ds_read_b64_tr_b16 v[120:121], v251 offset:20480
    ds_read_b64_tr_b16 v[122:123], v251 offset:21504
    ds_read_b64_tr_b16 v[124:125], v250 offset:22528
    ds_read_b64_tr_b16 v[126:127], v250 offset:23552
    ds_read_b64_tr_b16 v[128:129], v251 offset:22528
    ds_read_b64_tr_b16 v[130:131], v251 offset:23552
    ds_read_b64_tr_b16 v[132:133], v250 offset:24576
    ds_read_b64_tr_b16 v[134:135], v250 offset:25600
    ds_read_b64_tr_b16 v[136:137], v251 offset:24576
    ds_read_b64_tr_b16 v[138:139], v251 offset:25600
    ds_read_b64_tr_b16 v[140:141], v250 offset:26624
    ds_read_b64_tr_b16 v[142:143], v250 offset:27648
    ds_read_b64_tr_b16 v[144:145], v251 offset:26624
    ds_read_b64_tr_b16 v[146:147], v251 offset:27648
    ds_read_b64_tr_b16 v[148:149], v250 offset:28672
    ds_read_b64_tr_b16 v[150:151], v250 offset:29696
    ds_read_b64_tr_b16 v[152:153], v251 offset:28672
    ds_read_b64_tr_b16 v[154:155], v251 offset:29696
    ds_read_b64_tr_b16 v[156:157], v250 offset:30720
    ds_read_b64_tr_b16 v[158:159], v250 offset:31744
    ds_read_b64_tr_b16 v[160:161], v251 offset:30720
    ds_read_b64_tr_b16 v[162:163], v251 offset:31744
    s_xor_b32 s36, s3, 2
    s_lshl_b32 s36, s36, 12
    s_add_u32 s36, s36, 65536
    v_add_u32 v240, s36, v1
    s_lshl_b32 s36, s3, 12
    s_add_u32 s36, s36, 65536
    v_add_u32 v241, s36, v1
    v_and_b32 v2, 31, v0
    v_lshlrev_b32 v2, 11, v2
    v_lshrrev_b32 v3, 5, v0
    v_lshl_add_u32 v2, v3, 4, v2
    s_lshl_b32 s36, s32, 16
    s_lshl_b32 s37, s34, 6
    s_add_u32 s36, s36, s37
    s_lshl_b32 s37, s30, 2
    s_add_u32 s37, s37, 160776
    s_waitcnt lgkmcnt(0)
    s_waitcnt vmcnt(15)
    v_mfma_f32_32x32x16_bf16 v[20:35], v[40:43], v[164:167], 0
    s_waitcnt vmcnt(14)
    v_mfma_f32_32x32x16_bf16 v[20:35], v[48:51], v[168:171], v[20:35]
    s_waitcnt vmcnt(13)
    v_mfma_f32_32x32x16_bf16 v[20:35], v[56:59], v[172:175], v[20:35]
    s_waitcnt vmcnt(12)
    v_mfma_f32_32x32x16_bf16 v[20:35], v[64:67], v[176:179], v[20:35]
    s_waitcnt vmcnt(11)
    v_mfma_f32_32x32x16_bf16 v[20:35], v[72:75], v[180:183], v[20:35]
    s_waitcnt vmcnt(10)
    v_mfma_f32_32x32x16_bf16 v[20:35], v[80:83], v[184:187], v[20:35]
    s_waitcnt vmcnt(9)
    v_mfma_f32_32x32x16_bf16 v[20:35], v[88:91], v[188:191], v[20:35]
    s_waitcnt vmcnt(8)
    v_mfma_f32_32x32x16_bf16 v[20:35], v[96:99], v[192:195], v[20:35]
    s_waitcnt vmcnt(7)
    v_mfma_f32_32x32x16_bf16 v[20:35], v[104:107], v[196:199], v[20:35]
    s_waitcnt vmcnt(6)
    v_mfma_f32_32x32x16_bf16 v[20:35], v[112:115], v[200:203], v[20:35]
    s_waitcnt vmcnt(5)
    v_mfma_f32_32x32x16_bf16 v[20:35], v[120:123], v[204:207], v[20:35]
    s_waitcnt vmcnt(4)
    v_mfma_f32_32x32x16_bf16 v[20:35], v[128:131], v[208:211], v[20:35]
    s_waitcnt vmcnt(3)
    v_mfma_f32_32x32x16_bf16 v[20:35], v[136:139], v[212:215], v[20:35]
    s_waitcnt vmcnt(2)
    v_mfma_f32_32x32x16_bf16 v[20:35], v[144:147], v[216:219], v[20:35]
    s_waitcnt vmcnt(1)
    v_mfma_f32_32x32x16_bf16 v[20:35], v[152:155], v[220:223], v[20:35]
    s_waitcnt vmcnt(0)
    v_mfma_f32_32x32x16_bf16 v[20:35], v[160:163], v[224:227], v[20:35]
    v_mfma_f32_32x32x16_bf16 v[4:19], v[36:39], v[164:167], 0
    s_nop 7
    v_mfma_f32_32x32x16_bf16 v[4:19], v[44:47], v[168:171], v[4:19]
    s_nop 1
    ds_write_b128 v240, v[20:23] offset:0
    v_mfma_f32_32x32x16_bf16 v[4:19], v[52:55], v[172:175], v[4:19]
    ds_write_b128 v240, v[24:27] offset:1024
    v_mfma_f32_32x32x16_bf16 v[4:19], v[60:63], v[176:179], v[4:19]
    ds_write_b128 v240, v[28:31] offset:2048
    v_mfma_f32_32x32x16_bf16 v[4:19], v[68:71], v[180:183], v[4:19]
    ds_write_b128 v240, v[32:35] offset:3072
    v_mfma_f32_32x32x16_bf16 v[4:19], v[76:79], v[184:187], v[4:19]
    v_mov_b32 v242, s37
    v_mov_b32 v243, 1
    s_mov_b64 exec, 1
    s_waitcnt lgkmcnt(0)
    ds_add_u32 v242, v243 offset:0
    s_mov_b64 exec, -1
    v_mfma_f32_32x32x16_bf16 v[4:19], v[84:87], v[188:191], v[4:19]
    v_mfma_f32_32x32x16_bf16 v[4:19], v[92:95], v[192:195], v[4:19]
    v_mfma_f32_32x32x16_bf16 v[4:19], v[100:103], v[196:199], v[4:19]
    v_mfma_f32_32x32x16_bf16 v[4:19], v[108:111], v[200:203], v[4:19]
    v_mfma_f32_32x32x16_bf16 v[4:19], v[116:119], v[204:207], v[4:19]
    v_mfma_f32_32x32x16_bf16 v[4:19], v[124:127], v[208:211], v[4:19]
    s_mov_b64 exec, 1
    s_mov_b32 s39, 0
P3_S3:
    ds_read_b32 v243, v242 offset:0
    s_add_u32 s39, s39, 1
    s_waitcnt lgkmcnt(0)
    v_cmp_gt_u32 vcc, 2, v243
    s_cmp_ge_u32 s39, 3200000
    s_cbranch_scc1 P3_S3_D
    s_cbranch_vccz P3_S3_D
    s_sleep 0
    s_branch P3_S3
P3_S3_D:
    s_mov_b64 exec, -1
    ds_read_b128 v[20:23], v241 offset:0
    v_mfma_f32_32x32x16_bf16 v[4:19], v[132:135], v[212:215], v[4:19]
    ds_read_b128 v[24:27], v241 offset:1024
    v_mfma_f32_32x32x16_bf16 v[4:19], v[140:143], v[216:219], v[4:19]
    ds_read_b128 v[28:31], v241 offset:2048
    v_mfma_f32_32x32x16_bf16 v[4:19], v[148:151], v[220:223], v[4:19]
    ds_read_b128 v[32:35], v241 offset:3072
    v_mfma_f32_32x32x16_bf16 v[4:19], v[156:159], v[224:227], v[4:19]
    s_nop 11
    s_waitcnt lgkmcnt(3)
    v_add_f32 v4, v4, v20
    v_add_f32 v5, v5, v21
    v_add_f32 v6, v6, v22
    v_add_f32 v7, v7, v23
    v_cvt_pk_bf16_f32 v36, v4, v5
    v_cvt_pk_bf16_f32 v37, v6, v7
    s_waitcnt lgkmcnt(2)
    v_add_f32 v8, v8, v24
    v_add_f32 v9, v9, v25
    v_add_f32 v10, v10, v26
    v_add_f32 v11, v11, v27
    v_cvt_pk_bf16_f32 v38, v8, v9
    v_cvt_pk_bf16_f32 v39, v10, v11
    s_waitcnt lgkmcnt(1)
    v_add_f32 v12, v12, v28
    v_add_f32 v13, v13, v29
    v_add_f32 v14, v14, v30
    v_add_f32 v15, v15, v31
    v_cvt_pk_bf16_f32 v40, v12, v13
    v_cvt_pk_bf16_f32 v41, v14, v15
    s_waitcnt lgkmcnt(0)
    v_add_f32 v16, v16, v32
    v_add_f32 v17, v17, v33
    v_add_f32 v18, v18, v34
    v_add_f32 v19, v19, v35
    v_cvt_pk_bf16_f32 v42, v16, v17
    v_cvt_pk_bf16_f32 v43, v18, v19
    s_nop 1
    v_permlane32_swap_b32 v36, v38
    v_permlane32_swap_b32 v37, v39
    v_permlane32_swap_b32 v40, v42
    v_permlane32_swap_b32 v41, v43
    s_nop 1
    buffer_store_dwordx4 v[36:39], v2, s[16:19], s36 offen
    buffer_store_dwordx4 v[40:43], v2, s[16:19], s36 offen offset:32
    s_add_u32 s38, s2, s3
    s_cmp_lg_u32 s38, 0
    s_cbranch_scc1 P3_NE
    s_mov_b32 s38, 0xd00000
    v_mov_b32 v5, 0
    s_mov_b64 exec, 1
    buffer_store_dwordx2 v[252:253], v5, s[20:23], s38 offen sc1
P3_NE:
    s_endpgm
P2_AUX:
    s_and_b32 s58, s3, 3
    s_mul_i32 s58, s58, 15504
    s_add_u32 s58, s58, 16384
    v_lshl_add_u32 v78, v0, 2, s58
    v_mul_u32_u24 v79, 272, v2
    v_lshl_add_u32 v79, v3, 4, v79
    v_add_u32 v79, s58, v79
    s_mul_i32 s58, s55, 8320
    s_add_u32 s58, s58, 131072
    v_add_u32 v88, s58, v1
    v_mov_b32 v168, 0
    v_mov_b32 v169, 0
    v_mov_b32 v170, 0
    v_mov_b32 v171, 0
    v_mov_b32 v172, 0
    v_mov_b32 v173, 0
    v_mov_b32 v174, 0
    v_mov_b32 v175, 0
    v_mov_b32 v176, 0
    v_mov_b32 v177, 0
    v_mov_b32 v178, 0
    v_mov_b32 v179, 0
    v_lshlrev_b32 v86, 16, v86
    v_lshlrev_b32 v81, 16, v81
    v_mul_f32 v86, 0x3fb8aa3b, v86
    v_lshlrev_b32 v80, 16, v80
    v_exp_f32 v86, v86
    v_lshlrev_b32 v82, 16, v82
    v_lshlrev_b32 v83, 16, v83
    v_cvt_pk_bf16_f32 v86, v86, v86
    v_lshlrev_b32 v84, 16, v84
    v_lshlrev_b32 v86, 16, v86
    v_lshlrev_b32 v85, 16, v85
    v_mul_f32 v81, v86, v81
    v_mul_f32 v80, v86, v80
    v_mul_f32 v81, 0x3e22f983, v81
    v_mul_f32 v80, 0x3fb8aa3b, v80
    v_mul_f32 v241, 0x3f800000, v81
    v_mul_f32 v240, 0x3f800000, v80
    v_fract_f32 v241, v241
    v_mul_f32 v237, 0x41000000, v81
    v_exp_f32 v240, v240
    v_cos_f32 v242, v241
    v_sin_f32 v243, v241
    v_mul_f32 v236, 0x41000000, v80
    v_fract_f32 v237, v237
    v_mul_f32 v245, 0x43000000, v81
    v_exp_f32 v236, v236
    v_cos_f32 v238, v237
    v_sin_f32 v239, v237
    v_mul_f32 v244, 0x43000000, v80
    v_fract_f32 v245, v245
    v_mul_f32 v40, v240, v242
    v_mul_f32 v41, v240, v243
    v_exp_f32 v244, v244
    v_cos_f32 v246, v245
    v_sin_f32 v247, v245
    v_pk_mul_f32 v[74:75], v[40:41], v[40:41] op_sel:[0,0] op_sel_hi:[1,0]
    v_mul_f32 v82, v86, v82
    v_mul_f32 v83, v86, v83
    v_mul_f32 v38, v236, v238
    v_mul_f32 v39, v236, v239
    v_mul_f32 v36, v84, v82
    v_cvt_pk_bf16_f32 v249, v38, -v39
    v_mul_f32 v37, v84, v83
    ds_write_b32 v78, v249 offset:272
    v_pk_mul_f32 v[44:45], v[38:39], v[38:39] op_sel:[0,0] op_sel_hi:[1,0]
    v_pk_fma_f32 v[74:75], v[40:41], v[40:41], v[74:75] op_sel:[1,1,0] op_sel_hi:[0,1,1] neg_lo:[1,0,0]
    v_mul_f32 v42, v244, v246
    v_mul_f32 v43, v244, v247
    v_fma_f32 v36, -v85, v83, v36
    v_fma_f32 v37, v85, v82, v37
    v_pk_fma_f32 v[44:45], v[38:39], v[38:39], v[44:45] op_sel:[1,1,0] op_sel_hi:[0,1,1] neg_lo:[1,0,0]
    v_cvt_pk_bf16_f32 v244, v36, v37
    v_pk_mul_f32 v[94:95], v[74:75], v[74:75] op_sel:[0,0] op_sel_hi:[1,0]
    ds_write_b32 v78, v244 offset:4352
    v_cvt_pk_bf16_f32 v250, v44, -v45
    v_pk_mul_f32 v[120:121], v[42:43], v[42:43] op_sel:[0,0] op_sel_hi:[1,0]
    v_pk_mul_f32 v[72:73], v[36:37], v[40:41] op_sel:[0,0] op_sel_hi:[1,0]
    ds_write_b32 v78, v250 offset:544
    v_pk_mul_f32 v[46:47], v[44:45], v[38:39] op_sel:[0,0] op_sel_hi:[1,0]
    v_pk_mul_f32 v[48:49], v[44:45], v[44:45] op_sel:[0,0] op_sel_hi:[1,0]
    v_pk_fma_f32 v[94:95], v[74:75], v[74:75], v[94:95] op_sel:[1,1,0] op_sel_hi:[0,1,1] neg_lo:[1,0,0]
    v_pk_fma_f32 v[120:121], v[42:43], v[42:43], v[120:121] op_sel:[1,1,0] op_sel_hi:[0,1,1] neg_lo:[1,0,0]
    v_pk_fma_f32 v[72:73], v[36:37], v[40:41], v[72:73] op_sel:[1,1,0] op_sel_hi:[0,1,1] neg_lo:[1,0,0]
    v_pk_fma_f32 v[46:47], v[44:45], v[38:39], v[46:47] op_sel:[1,1,0] op_sel_hi:[0,1,1] neg_lo:[1,0,0]
    v_pk_fma_f32 v[48:49], v[44:45], v[44:45], v[48:49] op_sel:[1,1,0] op_sel_hi:[0,1,1] neg_lo:[1,0,0]
    s_mov_b64 exec, 0xff
    s_waitcnt vmcnt(0)
    buffer_store_dwordx2 v[6:7], v4, s[20:23], s52 offen sc1
    s_mov_b64 exec, -1
    v_cvt_pk_bf16_f32 v246, v72, v73
    v_cvt_pk_bf16_f32 v251, v46, -v47
    ds_write_b32 v78, v246 offset:4624
    v_cvt_pk_bf16_f32 v252, v48, -v49
    v_pk_mul_f32 v[90:91], v[36:37], v[74:75] op_sel:[0,0] op_sel_hi:[1,0]
    v_pk_mul_f32 v[96:97], v[36:37], v[94:95] op_sel:[0,0] op_sel_hi:[1,0]
    ds_write_b32 v78, v251 offset:816
    v_pk_mul_f32 v[104:105], v[36:37], v[42:43] op_sel:[0,0] op_sel_hi:[1,0]
    v_pk_mul_f32 v[138:139], v[120:121], v[120:121] op_sel:[0,0] op_sel_hi:[1,0]
    v_pk_mul_f32 v[92:93], v[72:73], v[74:75] op_sel:[0,0] op_sel_hi:[1,0]
    ds_write_b32 v78, v252 offset:1088
    v_pk_mul_f32 v[50:51], v[48:49], v[38:39] op_sel:[0,0] op_sel_hi:[1,0]
    v_pk_mul_f32 v[52:53], v[48:49], v[44:45] op_sel:[0,0] op_sel_hi:[1,0]
    v_pk_mul_f32 v[54:55], v[48:49], v[46:47] op_sel:[0,0] op_sel_hi:[1,0]
    v_pk_mul_f32 v[56:57], v[48:49], v[48:49] op_sel:[0,0] op_sel_hi:[1,0]
    v_pk_fma_f32 v[90:91], v[36:37], v[74:75], v[90:91] op_sel:[1,1,0] op_sel_hi:[0,1,1] neg_lo:[1,0,0]
    v_pk_fma_f32 v[96:97], v[36:37], v[94:95], v[96:97] op_sel:[1,1,0] op_sel_hi:[0,1,1] neg_lo:[1,0,0]
    v_pk_fma_f32 v[104:105], v[36:37], v[42:43], v[104:105] op_sel:[1,1,0] op_sel_hi:[0,1,1] neg_lo:[1,0,0]
    v_pk_fma_f32 v[138:139], v[120:121], v[120:121], v[138:139] op_sel:[1,1,0] op_sel_hi:[0,1,1] neg_lo:[1,0,0]
    v_cvt_pk_bf16_f32 v252, v96, v97
    v_cvt_pk_bf16_f32 v245, v104, v105
    ds_write_b32 v78, v252 offset:5440
    v_pk_fma_f32 v[92:93], v[72:73], v[74:75], v[92:93] op_sel:[1,1,0] op_sel_hi:[0,1,1] neg_lo:[1,0,0]
    v_pk_fma_f32 v[50:51], v[48:49], v[38:39], v[50:51] op_sel:[1,1,0] op_sel_hi:[0,1,1] neg_lo:[1,0,0]
    v_pk_fma_f32 v[52:53], v[48:49], v[44:45], v[52:53] op_sel:[1,1,0] op_sel_hi:[0,1,1] neg_lo:[1,0,0]
    ds_write_b32 v78, v245 offset:6528
    v_cvt_pk_bf16_f32 v253, v50, -v51
    v_cvt_pk_bf16_f32 v254, v52, -v53
    v_cvt_pk_bf16_f32 v250, v92, v93
    ds_write_b32 v78, v253 offset:1360
    v_pk_fma_f32 v[54:55], v[48:49], v[46:47], v[54:55] op_sel:[1,1,0] op_sel_hi:[0,1,1] neg_lo:[1,0,0]
    v_pk_fma_f32 v[56:57], v[48:49], v[48:49], v[56:57] op_sel:[1,1,0] op_sel_hi:[0,1,1] neg_lo:[1,0,0]
    v_pk_mul_f32 v[100:101], v[90:91], v[94:95] op_sel:[0,0] op_sel_hi:[1,0]
    ds_write_b32 v78, v254 offset:1632
    v_cvt_pk_bf16_f32 v255, v54, -v55
    v_cvt_pk_bf16_f32 v236, v56, -v57
    v_pk_mul_f32 v[112:113], v[96:97], v[42:43] op_sel:[0,0] op_sel_hi:[1,0]
    ds_write_b32 v78, v255 offset:1904
    v_pk_mul_f32 v[122:123], v[36:37], v[120:121] op_sel:[0,0] op_sel_hi:[1,0]
    v_pk_mul_f32 v[130:131], v[104:105], v[120:121] op_sel:[0,0] op_sel_hi:[1,0]
    v_pk_mul_f32 v[156:157], v[138:139], v[138:139] op_sel:[0,0] op_sel_hi:[1,0]
    ds_write_b32 v78, v236 offset:2176
    v_pk_mul_f32 v[98:99], v[72:73], v[94:95] op_sel:[0,0] op_sel_hi:[1,0]
    v_pk_mul_f32 v[102:103], v[92:93], v[94:95] op_sel:[0,0] op_sel_hi:[1,0]
    v_pk_mul_f32 v[108:109], v[90:91], v[42:43] op_sel:[0,0] op_sel_hi:[1,0]
    ds_write_b32 v78, v250 offset:5168
    v_pk_mul_f32 v[58:59], v[56:57], v[38:39] op_sel:[0,0] op_sel_hi:[1,0]
    v_pk_mul_f32 v[60:61], v[56:57], v[44:45] op_sel:[0,0] op_sel_hi:[1,0]
    v_pk_mul_f32 v[62:63], v[56:57], v[46:47] op_sel:[0,0] op_sel_hi:[1,0]
    v_pk_mul_f32 v[64:65], v[56:57], v[48:49] op_sel:[0,0] op_sel_hi:[1,0]
    v_pk_mul_f32 v[66:67], v[56:57], v[50:51] op_sel:[0,0] op_sel_hi:[1,0]
    v_pk_mul_f32 v[68:69], v[56:57], v[52:53] op_sel:[0,0] op_sel_hi:[1,0]
    v_pk_mul_f32 v[70:71], v[56:57], v[54:55] op_sel:[0,0] op_sel_hi:[1,0]
    v_pk_fma_f32 v[100:101], v[90:91], v[94:95], v[100:101] op_sel:[1,1,0] op_sel_hi:[0,1,1] neg_lo:[1,0,0]
    v_pk_fma_f32 v[112:113], v[96:97], v[42:43], v[112:113] op_sel:[1,1,0] op_sel_hi:[0,1,1] neg_lo:[1,0,0]
    v_pk_fma_f32 v[122:123], v[36:37], v[120:121], v[122:123] op_sel:[1,1,0] op_sel_hi:[0,1,1] neg_lo:[1,0,0]
    v_cvt_pk_bf16_f32 v236, v100, v101
    v_cvt_pk_bf16_f32 v253, v112, v113
    ds_write_b32 v78, v236 offset:5984
    v_pk_fma_f32 v[130:131], v[104:105], v[120:121], v[130:131] op_sel:[1,1,0] op_sel_hi:[0,1,1] neg_lo:[1,0,0]
    v_pk_fma_f32 v[156:157], v[138:139], v[138:139], v[156:157] op_sel:[1,1,0] op_sel_hi:[0,1,1] neg_lo:[1,0,0]
    v_pk_fma_f32 v[98:99], v[72:73], v[94:95], v[98:99] op_sel:[1,1,0] op_sel_hi:[0,1,1] neg_lo:[1,0,0]
    ds_write_b32 v78, v253 offset:7616
    v_pk_fma_f32 v[102:103], v[92:93], v[94:95], v[102:103] op_sel:[1,1,0] op_sel_hi:[0,1,1] neg_lo:[1,0,0]
    v_cvt_pk_bf16_f32 v254, v98, v99
    v_pk_fma_f32 v[108:109], v[90:91], v[42:43], v[108:109] op_sel:[1,1,0] op_sel_hi:[0,1,1] neg_lo:[1,0,0]
    ds_write_b32 v78, v254 offset:5712
    v_pk_fma_f32 v[58:59], v[56:57], v[38:39], v[58:59] op_sel:[1,1,0] op_sel_hi:[0,1,1] neg_lo:[1,0,0]
    v_cvt_pk_bf16_f32 v249, v108, v109
    v_pk_fma_f32 v[60:61], v[56:57], v[44:45], v[60:61] op_sel:[1,1,0] op_sel_hi:[0,1,1] neg_lo:[1,0,0]
    ds_write_b32 v78, v249 offset:7072
    v_cvt_pk_bf16_f32 v237, v58, -v59
    v_cvt_pk_bf16_f32 v238, v60, -v61
    v_pk_fma_f32 v[62:63], v[56:57], v[46:47], v[62:63] op_sel:[1,1,0] op_sel_hi:[0,1,1] neg_lo:[1,0,0]
    ds_write_b32 v78, v237 offset:2448
    v_pk_fma_f32 v[64:65], v[56:57], v[48:49], v[64:65] op_sel:[1,1,0] op_sel_hi:[0,1,1] neg_lo:[1,0,0]
    v_cvt_pk_bf16_f32 v239, v62, -v63
    v_pk_fma_f32 v[66:67], v[56:57], v[50:51], v[66:67] op_sel:[1,1,0] op_sel_hi:[0,1,1] neg_lo:[1,0,0]
    ds_write_b32 v78, v238 offset:2720
    v_cvt_pk_bf16_f32 v240, v64, -v65
    v_cvt_pk_bf16_f32 v241, v66, -v67
    v_pk_fma_f32 v[68:69], v[56:57], v[52:53], v[68:69] op_sel:[1,1,0] op_sel_hi:[0,1,1] neg_lo:[1,0,0]
    ds_write_b32 v78, v239 offset:2992
    v_pk_fma_f32 v[70:71], v[56:57], v[54:55], v[70:71] op_sel:[1,1,0] op_sel_hi:[0,1,1] neg_lo:[1,0,0]
    v_pk_mul_f32 v[116:117], v[100:101], v[42:43] op_sel:[0,0] op_sel_hi:[1,0]
    v_pk_mul_f32 v[126:127], v[96:97], v[120:121] op_sel:[0,0] op_sel_hi:[1,0]
    ds_write_b32 v78, v240 offset:3264
    v_cvt_pk_bf16_f32 v242, v68, -v69
    v_cvt_pk_bf16_f32 v243, v70, -v71
    v_pk_mul_f32 v[134:135], v[112:113], v[120:121] op_sel:[0,0] op_sel_hi:[1,0]
    ds_write_b32 v78, v241 offset:3536
    v_pk_mul_f32 v[140:141], v[36:37], v[138:139] op_sel:[0,0] op_sel_hi:[1,0]
    v_pk_mul_f32 v[144:145], v[104:105], v[138:139] op_sel:[0,0] op_sel_hi:[1,0]
    v_pk_mul_f32 v[148:149], v[122:123], v[138:139] op_sel:[0,0] op_sel_hi:[1,0]
    ds_write_b32 v78, v242 offset:3808
    v_cvt_pk_bf16_f32 v238, v102, v103
    v_cvt_pk_bf16_f32 v240, v122, v123
    v_pk_mul_f32 v[152:153], v[130:131], v[138:139] op_sel:[0,0] op_sel_hi:[1,0]
    ds_write_b32 v78, v243 offset:4080
    v_pk_mul_f32 v[158:159], v[36:37], v[156:157] op_sel:[0,0] op_sel_hi:[1,0]
    v_pk_mul_f32 v[106:107], v[72:73], v[42:43] op_sel:[0,0] op_sel_hi:[1,0]
    v_pk_mul_f32 v[110:111], v[92:93], v[42:43] op_sel:[0,0] op_sel_hi:[1,0]
    ds_write_b32 v78, v238 offset:6256
    v_cvt_pk_bf16_f32 v241, v130, v131
    v_pk_mul_f32 v[114:115], v[98:99], v[42:43] op_sel:[0,0] op_sel_hi:[1,0]
    v_pk_mul_f32 v[118:119], v[102:103], v[42:43] op_sel:[0,0] op_sel_hi:[1,0]
    ds_write_b32 v78, v240 offset:8704
    v_pk_mul_f32 v[124:125], v[90:91], v[120:121] op_sel:[0,0] op_sel_hi:[1,0]
    v_pk_mul_f32 v[132:133], v[108:109], v[120:121] op_sel:[0,0] op_sel_hi:[1,0]
    v_mov_b32 v248, 0x3f80
    ds_write_b32 v78, v241 offset:9792
    v_pk_fma_f32 v[116:117], v[100:101], v[42:43], v[116:117] op_sel:[1,1,0] op_sel_hi:[0,1,1] neg_lo:[1,0,0]
    v_pk_fma_f32 v[126:127], v[96:97], v[120:121], v[126:127] op_sel:[1,1,0] op_sel_hi:[0,1,1] neg_lo:[1,0,0]
    v_pk_fma_f32 v[134:135], v[112:113], v[120:121], v[134:135] op_sel:[1,1,0] op_sel_hi:[0,1,1] neg_lo:[1,0,0]
    ds_write_b32 v78, v248
    v_cvt_pk_bf16_f32 v237, v116, v117
    v_cvt_pk_bf16_f32 v248, v90, v91
    v_cvt_pk_bf16_f32 v244, v126, v127
    ds_write_b32 v78, v248 offset:4896
    v_pk_fma_f32 v[140:141], v[36:37], v[138:139], v[140:141] op_sel:[1,1,0] op_sel_hi:[0,1,1] neg_lo:[1,0,0]
    v_pk_fma_f32 v[144:145], v[104:105], v[138:139], v[144:145] op_sel:[1,1,0] op_sel_hi:[0,1,1] neg_lo:[1,0,0]
    v_pk_fma_f32 v[148:149], v[122:123], v[138:139], v[148:149] op_sel:[1,1,0] op_sel_hi:[0,1,1] neg_lo:[1,0,0]
    ds_write_b32 v78, v237 offset:8160
    v_cvt_pk_bf16_f32 v245, v134, v135
    v_cvt_pk_bf16_f32 v248, v140, v141
    v_pk_fma_f32 v[152:153], v[130:131], v[138:139], v[152:153] op_sel:[1,1,0] op_sel_hi:[0,1,1] neg_lo:[1,0,0]
    ds_write_b32 v78, v244 offset:9248
    v_pk_fma_f32 v[158:159], v[36:37], v[156:157], v[158:159] op_sel:[1,1,0] op_sel_hi:[0,1,1] neg_lo:[1,0,0]
    v_pk_fma_f32 v[106:107], v[72:73], v[42:43], v[106:107] op_sel:[1,1,0] op_sel_hi:[0,1,1] neg_lo:[1,0,0]
    v_pk_fma_f32 v[110:111], v[92:93], v[42:43], v[110:111] op_sel:[1,1,0] op_sel_hi:[0,1,1] neg_lo:[1,0,0]
    ds_write_b32 v78, v245 offset:10336
    v_cvt_pk_bf16_f32 v247, v106, v107
    v_cvt_pk_bf16_f32 v251, v110, v111
    v_pk_fma_f32 v[114:115], v[98:99], v[42:43], v[114:115] op_sel:[1,1,0] op_sel_hi:[0,1,1] neg_lo:[1,0,0]
    ds_write_b32 v78, v247 offset:6800
    v_pk_fma_f32 v[118:119], v[102:103], v[42:43], v[118:119] op_sel:[1,1,0] op_sel_hi:[0,1,1] neg_lo:[1,0,0]
    v_pk_fma_f32 v[124:125], v[90:91], v[120:121], v[124:125] op_sel:[1,1,0] op_sel_hi:[0,1,1] neg_lo:[1,0,0]
    v_pk_fma_f32 v[132:133], v[108:109], v[120:121], v[132:133] op_sel:[1,1,0] op_sel_hi:[0,1,1] neg_lo:[1,0,0]
    ds_write_b32 v78, v251 offset:7344
    v_cvt_pk_bf16_f32 v255, v114, v115
    v_cvt_pk_bf16_f32 v239, v118, v119
    v_pk_mul_f32 v[128:129], v[100:101], v[120:121] op_sel:[0,0] op_sel_hi:[1,0]
    ds_write_b32 v78, v255 offset:7888
    v_pk_mul_f32 v[136:137], v[116:117], v[120:121] op_sel:[0,0] op_sel_hi:[1,0]
    v_pk_mul_f32 v[142:143], v[96:97], v[138:139] op_sel:[0,0] op_sel_hi:[1,0]
    v_pk_mul_f32 v[146:147], v[112:113], v[138:139] op_sel:[0,0] op_sel_hi:[1,0]
    ds_write_b32 v78, v239 offset:8432
    v_cvt_pk_bf16_f32 v242, v124, v125
    v_cvt_pk_bf16_f32 v243, v132, v133
    v_pk_mul_f32 v[150:151], v[126:127], v[138:139] op_sel:[0,0] op_sel_hi:[1,0]
    ds_write_b32 v78, v242 offset:8976
    v_pk_mul_f32 v[154:155], v[134:135], v[138:139] op_sel:[0,0] op_sel_hi:[1,0]
    v_pk_mul_f32 v[160:161], v[104:105], v[156:157] op_sel:[0,0] op_sel_hi:[1,0]
    v_pk_mul_f32 v[162:163], v[122:123], v[156:157] op_sel:[0,0] op_sel_hi:[1,0]
    ds_write_b32 v78, v243 offset:10064
    v_cvt_pk_bf16_f32 v250, v144, v145
    v_cvt_pk_bf16_f32 v252, v148, v149
    v_pk_mul_f32 v[164:165], v[130:131], v[156:157] op_sel:[0,0] op_sel_hi:[1,0]
    ds_write_b32 v78, v248 offset:10880
    v_pk_mul_f32 v[166:167], v[140:141], v[156:157] op_sel:[0,0] op_sel_hi:[1,0]
    v_pk_mul_f32 v[180:181], v[144:145], v[156:157] op_sel:[0,0] op_sel_hi:[1,0]
    v_pk_mul_f32 v[182:183], v[148:149], v[156:157] op_sel:[0,0] op_sel_hi:[1,0]
    ds_write_b32 v78, v250 offset:11424
    v_cvt_pk_bf16_f32 v254, v152, v153
    v_cvt_pk_bf16_f32 v236, v158, v159
    v_pk_mul_f32 v[184:185], v[152:153], v[156:157] op_sel:[0,0] op_sel_hi:[1,0]
    ds_write_b32 v78, v252 offset:11968
    v_pk_mul_f32 v[186:187], v[158:159], v[156:157] op_sel:[0,0] op_sel_hi:[1,0]
    v_pk_fma_f32 v[128:129], v[100:101], v[120:121], v[128:129] op_sel:[1,1,0] op_sel_hi:[0,1,1] neg_lo:[1,0,0]
    v_pk_fma_f32 v[136:137], v[116:117], v[120:121], v[136:137] op_sel:[1,1,0] op_sel_hi:[0,1,1] neg_lo:[1,0,0]
    ds_write_b32 v78, v254 offset:12512
    v_cvt_pk_bf16_f32 v246, v128, v129
    v_cvt_pk_bf16_f32 v247, v136, v137
    v_pk_fma_f32 v[142:143], v[96:97], v[138:139], v[142:143] op_sel:[1,1,0] op_sel_hi:[0,1,1] neg_lo:[1,0,0]
    ds_write_b32 v78, v246 offset:9520
    v_pk_fma_f32 v[146:147], v[112:113], v[138:139], v[146:147] op_sel:[1,1,0] op_sel_hi:[0,1,1] neg_lo:[1,0,0]
    v_pk_fma_f32 v[150:151], v[126:127], v[138:139], v[150:151] op_sel:[1,1,0] op_sel_hi:[0,1,1] neg_lo:[1,0,0]
    v_pk_fma_f32 v[154:155], v[134:135], v[138:139], v[154:155] op_sel:[1,1,0] op_sel_hi:[0,1,1] neg_lo:[1,0,0]
    ds_write_b32 v78, v247 offset:10608
    v_cvt_pk_bf16_f32 v249, v142, v143
    v_cvt_pk_bf16_f32 v251, v146, v147
    v_pk_fma_f32 v[160:161], v[104:105], v[156:157], v[160:161] op_sel:[1,1,0] op_sel_hi:[0,1,1] neg_lo:[1,0,0]
    ds_write_b32 v78, v249 offset:11152
    v_pk_fma_f32 v[162:163], v[122:123], v[156:157], v[162:163] op_sel:[1,1,0] op_sel_hi:[0,1,1] neg_lo:[1,0,0]
    v_pk_fma_f32 v[164:165], v[130:131], v[156:157], v[164:165] op_sel:[1,1,0] op_sel_hi:[0,1,1] neg_lo:[1,0,0]
    v_pk_fma_f32 v[166:167], v[140:141], v[156:157], v[166:167] op_sel:[1,1,0] op_sel_hi:[0,1,1] neg_lo:[1,0,0]
    ds_write_b32 v78, v251 offset:11696
    v_cvt_pk_bf16_f32 v253, v150, v151
    v_cvt_pk_bf16_f32 v255, v154, v155
    v_pk_fma_f32 v[180:181], v[144:145], v[156:157], v[180:181] op_sel:[1,1,0] op_sel_hi:[0,1,1] neg_lo:[1,0,0]
    ds_write_b32 v78, v253 offset:12240
    v_pk_fma_f32 v[182:183], v[148:149], v[156:157], v[182:183] op_sel:[1,1,0] op_sel_hi:[0,1,1] neg_lo:[1,0,0]
    v_pk_fma_f32 v[184:185], v[152:153], v[156:157], v[184:185] op_sel:[1,1,0] op_sel_hi:[0,1,1] neg_lo:[1,0,0]
    v_pk_fma_f32 v[186:187], v[158:159], v[156:157], v[186:187] op_sel:[1,1,0] op_sel_hi:[0,1,1] neg_lo:[1,0,0]
    ds_write_b32 v78, v255 offset:12784
    v_cvt_pk_bf16_f32 v237, v160, v161
    v_cvt_pk_bf16_f32 v238, v162, v163
    v_cvt_pk_bf16_f32 v239, v164, v165
    ds_write_b32 v78, v236 offset:13056
    v_cvt_pk_bf16_f32 v240, v166, v167
    v_cvt_pk_bf16_f32 v241, v180, v181
    v_cvt_pk_bf16_f32 v242, v182, v183
    ds_write_b32 v78, v237 offset:13328
    v_cvt_pk_bf16_f32 v243, v184, v185
    v_cvt_pk_bf16_f32 v244, v186, v187
    ds_write_b32 v78, v238 offset:13600
    ds_write_b32 v78, v239 offset:13872
    ds_write_b32 v78, v240 offset:14144
    ds_write_b32 v78, v241 offset:14416
    ds_write_b32 v78, v242 offset:14688
    ds_write_b32 v78, v243 offset:14960
    ds_write_b32 v78, v244 offset:15232
    ds_read_b128 v[90:93], v79 offset:0
    ds_read_b128 v[94:97], v79 offset:64
    ds_read_b128 v[98:101], v79 offset:128
    ds_read_b128 v[102:105], v79 offset:192
    ds_read_b128 v[106:109], v79 offset:4352
    ds_read_b128 v[110:113], v79 offset:4416
    ds_read_b128 v[114:117], v79 offset:4480
    ds_read_b128 v[118:121], v79 offset:4544
    ds_read_b128 v[122:125], v79 offset:8704
    ds_read_b128 v[126:129], v79 offset:8768
    ds_read_b128 v[130:133], v79 offset:8832
    ds_read_b128 v[134:137], v79 offset:8896
    ds_read_b128 v[138:141], v79 offset:13056
    ds_read_b128 v[142:145], v79 offset:13120
    ds_read_b128 v[146:149], v79 offset:13184
    ds_read_b128 v[150:153], v79 offset:13248
    s_waitcnt lgkmcnt(8)
    v_mfma_f32_16x16x32_bf16 v[168:171], v[106:109], v[90:93], v[168:171]
    v_mfma_f32_16x16x32_bf16 v[168:171], v[110:113], v[94:97], v[168:171]
    v_mfma_f32_16x16x32_bf16 v[168:171], v[114:117], v[98:101], v[168:171]
    v_mfma_f32_16x16x32_bf16 v[168:171], v[118:121], v[102:105], v[168:171]
    s_waitcnt lgkmcnt(4)
    v_mfma_f32_16x16x32_bf16 v[172:175], v[122:125], v[90:93], v[172:175]
    v_mfma_f32_16x16x32_bf16 v[172:175], v[126:129], v[94:97], v[172:175]
    v_mfma_f32_16x16x32_bf16 v[172:175], v[130:133], v[98:101], v[172:175]
    v_mfma_f32_16x16x32_bf16 v[172:175], v[134:137], v[102:105], v[172:175]
    s_waitcnt lgkmcnt(0)
    v_mfma_f32_16x16x32_bf16 v[176:179], v[138:141], v[90:93], v[176:179]
    v_mfma_f32_16x16x32_bf16 v[176:179], v[142:145], v[94:97], v[176:179]
    v_mfma_f32_16x16x32_bf16 v[176:179], v[146:149], v[98:101], v[176:179]
    v_mfma_f32_16x16x32_bf16 v[176:179], v[150:153], v[102:105], v[176:179]
    s_cmp_eq_u32 s30, 0
    s_cbranch_scc1 KG_EV
    s_nop 7
    ds_write_b128 v88, v[168:171]
    ds_write_b128 v88, v[172:175] offset:1024
    ds_write_b128 v88, v[176:179] offset:2048
KG_EV:
    s_setprio 0
    s_mov_b32 s16, s10
    s_mov_b32 s17, s11
    s_mov_b32 s18, 0x400000
    s_mov_b32 s19, 0x00020000
    s_sub_u32 s3, s3, 4
    s_lshl_b32 s31, s3, 10
    s_add_u32 m0, s31, 16384
    s_lshl_b32 s30, s27, 14
    s_add_u32 s30, s30, s31
    s_add_u32 s30, s30, 16384
    s_and_b32 s30, s30, 0x1ffff
    v_mov_b32 v8, 160768
    v_mov_b32 v12, 0
    v_mov_b32 v13, 0
    v_mov_b32 v14, 0
    v_mov_b32 v15, 0
    ds_write_b128 v8, v[12:15]
    ds_write_b128 v8, v[12:15] offset:16
    ds_write_b128 v8, v[12:15] offset:32
    v_lshlrev_b32 v5, 3, v0
    s_waitcnt lgkmcnt(0)
    s_barrier
    s_mov_b32 s39, 0
P2_POLA:
    s_sleep 2
    buffer_load_dwordx2 v[140:141], v5, s[20:23], s36 offen sc1
    s_waitcnt vmcnt(0)
P2_POLA_C:
    v_cmp_ne_u64 vcc, v[140:141], v[6:7]
    s_add_u32 s39, s39, 1
    s_cmp_ge_u32 s39, 400000
    s_cbranch_scc1 P2_POLA_D
    s_cbranch_vccnz P2_POLA
P2_POLA_D:
    s_add_u32 s38, s30, s37
    buffer_load_dwordx4 v1, s[20:23], s38 offen sc1 lds
    s_add_u32 m0, m0, 4096
    s_add_u32 s30, s30, 4096
    s_and_b32 s30, s30, 0x1ffff
    s_add_u32 s38, s30, s37
    buffer_load_dwordx4 v1, s[20:23], s38 offen sc1 lds
    s_add_u32 m0, m0, 4096
    s_add_u32 s30, s30, 4096
    s_and_b32 s30, s30, 0x1ffff
    s_add_u32 s38, s30, s37
    buffer_load_dwordx4 v1, s[20:23], s38 offen sc1 lds
    s_add_u32 m0, m0, 4096
    s_add_u32 s30, s30, 4096
    s_and_b32 s30, s30, 0x1ffff
    s_add_u32 s38, s30, s37
    buffer_load_dwordx4 v1, s[20:23], s38 offen sc1 lds
    s_add_u32 m0, m0, 4096
    s_add_u32 s30, s30, 4096
    s_and_b32 s30, s30, 0x1ffff
    s_add_u32 s38, s30, s37
    buffer_load_dwordx4 v1, s[20:23], s38 offen sc1 lds
    s_add_u32 m0, m0, 4096
    s_add_u32 s30, s30, 4096
    s_and_b32 s30, s30, 0x1ffff
    s_add_u32 s38, s30, s37
    buffer_load_dwordx4 v1, s[20:23], s38 offen sc1 lds
    s_add_u32 m0, m0, 4096
    s_add_u32 s30, s30, 4096
    s_and_b32 s30, s30, 0x1ffff
    s_add_u32 s38, s30, s37
    buffer_load_dwordx4 v1, s[20:23], s38 offen sc1 lds
    s_add_u32 m0, m0, 4096
    s_add_u32 s30, s30, 4096
    s_and_b32 s30, s30, 0x1ffff
    s_add_u32 s38, s30, s37
    buffer_load_dwordx4 v1, s[20:23], s38 offen sc1 lds
    s_add_u32 m0, m0, 4096
    s_add_u32 s30, s30, 4096
    s_and_b32 s30, s30, 0x1ffff
    s_lshl_b32 s26, s24, 5
    s_add_u32 s26, s26, s25
    s_lshl_b32 s32, s26, 2
    s_lshr_b32 s33, s3, 1
    s_and_b32 s34, s3, 1
    v_mov_b32 v8, s32
    global_load_dword v16, v8, s[8:9]
    s_add_u32 s38, s30, s37
    buffer_load_dwordx4 v1, s[20:23], s38 offen sc1 lds
    s_add_u32 m0, m0, 4096
    s_add_u32 s30, s30, 4096
    s_and_b32 s30, s30, 0x1ffff
    s_add_u32 s38, s30, s37
    buffer_load_dwordx4 v1, s[20:23], s38 offen sc1 lds
    s_add_u32 m0, m0, 4096
    s_add_u32 s30, s30, 4096
    s_and_b32 s30, s30, 0x1ffff
    s_add_u32 s38, s30, s37
    buffer_load_dwordx4 v1, s[20:23], s38 offen sc1 lds
    s_add_u32 m0, m0, 4096
    s_add_u32 s30, s30, 4096
    s_and_b32 s30, s30, 0x1ffff
    s_add_u32 s38, s30, s37
    buffer_load_dwordx4 v1, s[20:23], s38 offen sc1 lds
    s_add_u32 m0, m0, 4096
    s_add_u32 s30, s30, 4096
    s_and_b32 s30, s30, 0x1ffff
    s_add_u32 s38, s30, s37
    buffer_load_dwordx4 v1, s[20:23], s38 offen sc1 lds
    s_add_u32 m0, m0, 4096
    s_add_u32 s30, s30, 4096
    s_and_b32 s30, s30, 0x1ffff
    s_add_u32 s38, s30, s37
    buffer_load_dwordx4 v1, s[20:23], s38 offen sc1 lds
    s_add_u32 m0, m0, 4096
    s_add_u32 s30, s30, 4096
    s_and_b32 s30, s30, 0x1ffff
    s_cmp_lg_u32 s34, 0
    s_cbranch_scc1 GS_END
    ds_read_b128 v[104:107], v88
    ds_read_b128 v[108:111], v88 offset:1024
    ds_read_b128 v[112:115], v88 offset:2048
    s_mul_i32 s58, s33, 1536
    s_add_u32 s58, s58, 157696
    v_lshrrev_b32 v120, 1, v3
    v_lshlrev_b32 v120, 8, v120
    v_lshl_add_u32 v120, v2, 4, v120
    v_and_b32 v121, 1, v3
    v_lshl_add_u32 v120, v121, 3, v120
    v_cmp_gt_u32 s[60:61], 2, v3
    v_lshlrev_b32 v122, 2, v2
    v_lshlrev_b32 v123, 3, v2
    v_cndmask_b32 v122, v122, v123, s[60:61]
    v_lshl_add_u32 v122, v3, 7, v122
    v_mov_b32 v123, 64
    v_cndmask_b32 v123, v123, 4, s[60:61]
    v_add_u32 v123, v122, v123
    v_lshlrev_b32 v124, 7, v3
    v_lshl_add_u32 v124, v2, 1, v124
    v_add_u32 v120, s58, v120
    v_add_u32 v122, s58, v122
    v_add_u32 v123, s58, v123
    v_add_u32 v124, s58, v124
    s_waitcnt lgkmcnt(0)
    v_add_f32 v168, v168, v104
    v_add_f32 v169, v169, v105
    v_add_f32 v170, v170, v106
    v_add_f32 v171, v171, v107
    v_add_f32 v172, v172, v108
    v_add_f32 v173, v173, v109
    v_add_f32 v174, v174, v110
    v_add_f32 v175, v175, v111
    v_add_f32 v176, v176, v112
    v_add_f32 v177, v177, v113
    v_add_f32 v178, v178, v114
    v_add_f32 v179, v179, v115
    v_cvt_pk_bf16_f32 v128, v168, v169
    v_cvt_pk_bf16_f32 v129, v170, v171
    v_cvt_pk_bf16_f32 v130, v172, v173
    v_cvt_pk_bf16_f32 v131, v174, v175
    v_cvt_pk_bf16_f32 v132, v176, v177
    v_cvt_pk_bf16_f32 v133, v178, v179
    ds_write_b64 v120, v[128:129]
    ds_write_b32 v122, v130 offset:512
    ds_write_b32 v123, v131 offset:512
    ds_write_b16 v124, v132 offset:1024
    ds_write_b16_d16_hi v124, v132 offset:1056
    ds_write_b16 v124, v133 offset:1088
    ds_write_b16_d16_hi v124, v133 offset:1120
GS_END:
    s_waitcnt vmcnt(7) lgkmcnt(0)
    s_barrier
    s_mul_i32 s35, s33, 1536
    s_add_u32 s35, s35, 157696
    v_lshl_add_u32 v5, v0, 3, s35
    v_lshl_add_u32 v6, v0, 2, s35
    v_mov_b32 v7, s35
    ds_read_b64 v[50:51], v5
    ds_read_b32 v52, v5 offset:8
    ds_read2_b32 v[54:55], v6 offset0:128 offset1:129
    ds_read2_b32 v[56:57], v6 offset0:192 offset1:193
    v_add_u32 v6, 1024, v6
    ds_read2_b32 v[58:59], v6 offset0:0 offset1:1
    ds_read_u16 v60, v7
    v_lshlrev_b32 v5, 3, v0
    s_add_u32 s38, s30, s37
    buffer_load_dwordx4 v1, s[20:23], s38 offen sc1 lds
    s_add_u32 m0, m0, 4096
    s_add_u32 s30, s30, 4096
    s_and_b32 s30, s30, 0x1ffff
    s_add_u32 s38, s30, s37
    buffer_load_dwordx4 v1, s[20:23], s38 offen sc1 lds
    s_add_u32 m0, m0, 4096
    s_add_u32 s30, s30, 4096
    s_and_b32 s30, s30, 0x1ffff
    s_add_u32 s38, s30, s37
    buffer_load_dwordx4 v1, s[20:23], s38 offen sc1 lds
    s_add_u32 m0, m0, 4096
    s_add_u32 s30, s30, 4096
    s_and_b32 s30, s30, 0x1ffff
    s_add_u32 s38, s30, s37
    buffer_load_dwordx4 v1, s[20:23], s38 offen sc1 lds
    s_add_u32 m0, m0, 4096
    s_add_u32 s30, s30, 4096
    s_and_b32 s30, s30, 0x1ffff
    s_add_u32 s38, s30, s37
    buffer_load_dwordx4 v1, s[20:23], s38 offen sc1 lds
    s_add_u32 m0, m0, 4096
    s_add_u32 s30, s30, 4096
    s_and_b32 s30, s30, 0x1ffff
    s_add_u32 s38, s30, s37
    buffer_load_dwordx4 v1, s[20:23], s38 offen sc1 lds
    s_add_u32 m0, m0, 4096
    s_add_u32 s30, s30, 4096
    s_and_b32 s30, s30, 0x1ffff
    s_add_u32 s38, s30, s37
    buffer_load_dwordx4 v1, s[20:23], s38 offen sc1 lds
    s_add_u32 m0, m0, 4096
    s_add_u32 s30, s30, 4096
    s_and_b32 s30, s30, 0x1ffff
    s_add_u32 s38, s30, s37
    buffer_load_dwordx4 v1, s[20:23], s38 offen sc1 lds
    s_add_u32 m0, m0, 4096
    s_add_u32 s30, s30, 4096
    s_and_b32 s30, s30, 0x1ffff
    s_add_u32 s38, s30, s37
    buffer_load_dwordx4 v1, s[20:23], s38 offen sc1 lds
    s_add_u32 m0, m0, 4096
    s_add_u32 s30, s30, 4096
    s_and_b32 s30, s30, 0x1ffff
    s_add_u32 s38, s30, s37
    buffer_load_dwordx4 v1, s[20:23], s38 offen sc1 lds
    s_add_u32 m0, m0, 4096
    s_add_u32 s30, s30, 4096
    s_and_b32 s30, s30, 0x1ffff
    s_add_u32 s38, s30, s37
    buffer_load_dwordx4 v1, s[20:23], s38 offen sc1 lds
    s_add_u32 m0, m0, 4096
    s_add_u32 s30, s30, 4096
    s_and_b32 s30, s30, 0x1ffff
    s_add_u32 s38, s30, s37
    buffer_load_dwordx4 v1, s[20:23], s38 offen sc1 lds
    s_add_u32 m0, m0, 4096
    s_add_u32 s30, s30, 4096
    s_and_b32 s30, s30, 0x1ffff
    s_add_u32 s38, s30, s37
    buffer_load_dwordx4 v1, s[20:23], s38 offen sc1 lds
    s_add_u32 m0, m0, 4096
    s_add_u32 s30, s30, 4096
    s_and_b32 s30, s30, 0x1ffff
    s_add_u32 s38, s30, s37
    buffer_load_dwordx4 v1, s[20:23], s38 offen sc1 lds
    s_add_u32 m0, m0, 4096
    s_add_u32 s30, s30, 4096
    s_and_b32 s30, s30, 0x1ffff
    s_mov_b32 s48, s6
    s_mov_b32 s49, s7
    s_mov_b32 s50, 0x200000
    s_mov_b32 s51, 0x00020000
    v_lshlrev_b32 v9, 10, v0
    s_lshl_b32 s36, s3, 19
    s_add_u32 s36, s36, s32
    v_mov_b32 v106, v9
    s_lshl_b32 s46, s3, 3
    s_add_u32 s46, s46, s25
    s_mov_b32 s12, s4
    s_mov_b32 s13, s5
    s_mov_b32 s14, 0x80000
    s_mov_b32 s15, 0x00020000
    s_add_u32 s47, s46, 0
    s_and_b32 s47, s47, 31
    s_lshl_b32 s52, s47, 7
    s_lshl_b32 s47, s47, 16
    s_add_u32 s47, s47, s32
    buffer_load_dword v96, v106, s[48:51], s47 offen
    s_add_u32 s47, s46, 1
    s_and_b32 s47, s47, 31
    s_lshl_b32 s53, s47, 7
    s_lshl_b32 s47, s47, 16
    s_add_u32 s47, s47, s32
    buffer_load_dword v97, v106, s[48:51], s47 offen
    s_add_u32 s47, s46, 2
    s_and_b32 s47, s47, 31
    s_lshl_b32 s54, s47, 7
    s_lshl_b32 s47, s47, 16
    s_add_u32 s47, s47, s32
    buffer_load_dword v98, v106, s[48:51], s47 offen
    s_add_u32 s47, s46, 3
    s_and_b32 s47, s47, 31
    s_lshl_b32 s55, s47, 7
    s_lshl_b32 s47, s47, 16
    s_add_u32 s47, s47, s32
    buffer_load_dword v99, v106, s[48:51], s47 offen
    s_add_u32 s47, s46, 4
    s_and_b32 s47, s47, 31
    s_lshl_b32 s56, s47, 7
    s_lshl_b32 s47, s47, 16
    s_add_u32 s47, s47, s32
    buffer_load_dword v100, v106, s[48:51], s47 offen
    s_add_u32 s47, s46, 5
    s_and_b32 s47, s47, 31
    s_lshl_b32 s57, s47, 7
    s_lshl_b32 s47, s47, 16
    s_add_u32 s47, s47, s32
    buffer_load_dword v101, v106, s[48:51], s47 offen
    s_add_u32 s47, s46, 6
    s_and_b32 s47, s47, 31
    s_lshl_b32 s58, s47, 7
    s_lshl_b32 s47, s47, 16
    s_add_u32 s47, s47, s32
    buffer_load_dword v102, v106, s[48:51], s47 offen
    v_lshlrev_b32 v105, 1, v0
    v_sub_u32 v105, 151806, v105
    v_and_b32 v2, 15, v0
    v_lshrrev_b32 v3, 4, v0
    s_lshl_b32 s27, s34, 1
    s_add_u32 s27, s27, s33
    s_lshl_b32 s27, s27, 1
    v_lshlrev_b32 v4, 2, v3
    v_lshl_add_u32 v4, v2, 4, v4
    v_lshlrev_b32 v9, 1, v4
    v_sub_u32 v9, 151800, v9
    v_lshlrev_b32 v4, 11, v4
    v_and_b32 v10, 1, v2
    v_mul_u32_u24 v17, 4160, v10
    v_add_u32 v11, v2, v10
    v_lshl_add_u32 v17, v11, 1, v17
    v_lshl_add_u32 v17, v3, 4, v17
    s_mul_i32 s35, s33, 8320
    s_lshl_b32 s36, s34, 8
    s_add_u32 s35, s35, s36
    s_add_u32 s35, s35, 131072
    v_add_u32 v17, s35, v17
    v_add_u32 v18, 1024, v17
    v_add_u32 v19, 2048, v17
    v_add_u32 v20, 3072, v17
    v_lshlrev_b32 v10, 5, v2
    v_lshlrev_b32 v11, 4, v3
    v_sub_u32 v11, v11, v10
    s_mul_i32 s35, s33, 4608
    s_add_u32 s35, s35, s36
    s_add_u32 s35, s35, 148192
    v_add_u32 v23, s35, v11
    s_lshl_b32 s35, s27, 9
    v_subrev_u32 v22, s35, v9
    v_subrev_u32 v21, 512, v22
    s_mul_i32 s38, s33, 8320
    s_xor_b32 s39, s34, 1
    s_mul_i32 s39, s39, 4160
    s_add_u32 s38, s38, s39
    s_add_u32 s38, s38, 131072
    v_add_u32 v5, s38, v5
    v_lshl_add_u32 v6, v0, 4, s38
    v_lshl_add_u32 v7, v0, 5, s38
    v_lshl_add_u32 v8, v0, 2, s38
    s_mul_i32 s39, s33, 4608
    s_add_u32 s39, s39, 151808
    v_lshl_add_u32 v10, v0, 3, s39
    s_mov_b32 s40, 0x01000100
    s_mov_b32 s41, 0x03020302
    v_mov_b32 v92, 0
    v_mov_b32 v93, 0
    v_cmp_eq_u32 s[42:43], 7, v0
    s_waitcnt lgkmcnt(0)
    s_cmp_eq_u32 s34, 0
    s_cbranch_scc0 K2_XO
    v_perm_b32 v64, v54, v54, s40
    v_alignbit_b32 v65, v55, v54, 16
    v_perm_b32 v68, v56, v56, s40
    v_mov_b32 v69, v56
    v_perm_b32 v70, v56, v56, s41
    v_perm_b32 v71, v57, v57, s40
    v_perm_b32 v76, v58, v58, s40
    v_mov_b32 v77, v76
    v_mov_b32 v78, v58
    v_perm_b32 v79, v58, v58, s41
    v_mov_b32 v80, v79
    v_mov_b32 v81, v79
    v_perm_b32 v82, v59, v59, s40
    v_mov_b32 v83, v82
    v_mov_b32 v60, 0
    ds_write_b64 v10, v[92:93]
    s_branch K2_XW
K2_XO:
    v_alignbit_b32 v50, v51, v50, 16
    v_alignbit_b32 v51, v52, v51, 16
    v_mov_b32 v64, v54
    v_perm_b32 v65, v55, v55, s40
    v_perm_b32 v68, v56, v56, s40
    v_perm_b32 v69, v56, v56, s41
    v_alignbit_b32 v70, v57, v56, 16
    v_perm_b32 v71, v57, v57, s40
    v_perm_b32 v76, v58, v58, s40
    v_mov_b32 v77, v76
    v_perm_b32 v78, v58, v58, s41
    v_mov_b32 v79, v78
    v_mov_b32 v80, v78
    v_alignbit_b32 v81, v59, v58, 16
    v_perm_b32 v82, v59, v59, s40
    v_mov_b32 v83, v82
    v_lshlrev_b32 v60, 16, v60
    v_cndmask_b32 v60, 0, v60, s[42:43]
K2_XW:
    ds_write_b64 v5, v[50:51] offset:32
    ds_write_b64 v5, v[64:65] offset:544
    ds_write_b128 v6, v[68:71] offset:1056
    ds_write_b128 v7, v[76:79] offset:2080
    ds_write_b128 v7, v[80:83] offset:2096
    s_mov_b64 exec, 0xff
    ds_write_b32 v8, v60
    s_mov_b64 exec, -1
    s_waitcnt vmcnt(7)
    s_barrier
    s_add_u32 s47, s46, 7
    s_and_b32 s47, s47, 31
    s_lshl_b32 s59, s47, 7
    s_lshl_b32 s47, s47, 16
    s_add_u32 s47, s47, s32
    buffer_load_dword v103, v106, s[48:51], s47 offen
    v_subrev_u32 v107, s52, v105
    s_waitcnt vmcnt(7)
    ds_write_b16 v107, v96
    ds_write_b16_d16_hi v107, v96 offset:4608
    v_subrev_u32 v108, s53, v105
    s_waitcnt vmcnt(6)
    ds_write_b16 v108, v97
    ds_write_b16_d16_hi v108, v97 offset:4608
    v_subrev_u32 v107, s54, v105
    s_waitcnt vmcnt(5)
    ds_write_b16 v107, v98
    ds_write_b16_d16_hi v107, v98 offset:4608
    v_subrev_u32 v108, s55, v105
    s_waitcnt vmcnt(4)
    ds_write_b16 v108, v99
    ds_write_b16_d16_hi v108, v99 offset:4608
    v_subrev_u32 v107, s56, v105
    s_waitcnt vmcnt(3)
    ds_write_b16 v107, v100
    ds_write_b16_d16_hi v107, v100 offset:4608
    v_subrev_u32 v108, s57, v105
    s_waitcnt vmcnt(2)
    ds_write_b16 v108, v101
    ds_write_b16_d16_hi v108, v101 offset:4608
    v_subrev_u32 v107, s58, v105
    s_waitcnt vmcnt(1)
    ds_write_b16 v107, v102
    ds_write_b16_d16_hi v107, v102 offset:4608
    v_subrev_u32 v108, s59, v105
    s_waitcnt vmcnt(0)
    ds_write_b16 v108, v103
    ds_write_b16_d16_hi v108, v103 offset:4608
    s_cmp_ge_u32 s3, 1
    s_cbranch_scc1 K2_NWU
    s_lshr_b32 s36, s25, 2
    s_lshl_b32 s36, s36, 16
    s_lshr_b32 s45, s24, 2
    s_lshl_b32 s45, s45, 2
    s_and_b32 s44, s25, 3
    s_add_u32 s45, s45, s44
    s_lshl_b32 s45, s45, 7
    s_add_u32 s36, s36, s45
    buffer_load_dword v110, v106, s[12:15], s36 offen
K2_NWU:
    s_waitcnt lgkmcnt(0)
    s_barrier
    s_waitcnt vmcnt(0)
    ds_read2_b32 v[24:25], v17 offset0:0 offset1:1
    ds_read2_b32 v[26:27], v17 offset0:2 offset1:3
    ds_read_b128 v[56:59], v23 offset:3584
    ds_read2_b32 v[28:29], v17 offset0:128 offset1:129
    ds_read2_b32 v[30:31], v17 offset0:130 offset1:131
    ds_read_b128 v[60:63], v23 offset:3072
    ds_read2_b32 v[32:33], v18 offset0:0 offset1:1
    ds_read2_b32 v[34:35], v18 offset0:2 offset1:3
    ds_read_b128 v[64:67], v23 offset:2560
    ds_read2_b32 v[36:37], v18 offset0:128 offset1:129
    ds_read2_b32 v[38:39], v18 offset0:130 offset1:131
    ds_read_b128 v[68:71], v23 offset:2048
    ds_read2_b32 v[40:41], v19 offset0:0 offset1:1
    ds_read2_b32 v[42:43], v19 offset0:2 offset1:3
    ds_read_b128 v[72:75], v23 offset:1536
    ds_read2_b32 v[44:45], v19 offset0:128 offset1:129
    ds_read2_b32 v[46:47], v19 offset0:130 offset1:131
    ds_read_b128 v[76:79], v23 offset:1024
    ds_read2_b32 v[48:49], v20 offset0:0 offset1:1
    ds_read2_b32 v[50:51], v20 offset0:2 offset1:3
    ds_read_b128 v[80:83], v23 offset:512
    ds_read2_b32 v[52:53], v20 offset0:128 offset1:129
    ds_read2_b32 v[54:55], v20 offset0:130 offset1:131
    ds_read_b128 v[84:87], v23 offset:0
    s_lshl_b32 s35, s3, 12
    s_add_u32 s35, s35, 131072
    v_add_u32 v184, s35, v1
    v_xor_b32 v185, 4096, v184
    s_lshl_b32 s35, s3, 11
    s_add_u32 s35, s35, 147456
    v_add_u32 v190, s35, v1
    v_xor_b32 v191, 4096, v190
    v_lshlrev_b32 v6, 16, v16
    v_and_b32 v7, 0xffff0000, v16
    s_lshl_b32 s44, s33, 2
    s_add_u32 s44, s44, 160788
    s_lshl_b32 s45, s34, 2
    s_add_u32 s45, s45, 160796
    s_lshl_b32 s40, s27, 19
    s_add_u32 s40, s40, s32
    s_add_u32 s40, s40, 1024
    s_add_u32 s41, s40, 4096
    s_add_u32 s42, s40, 524288
    s_add_u32 s43, s41, 524288
    ds_read_b64 v[8:9], v22
    ds_read_b64 v[10:11], v22 offset:4608
    ds_read_b64 v[12:13], v21
    ds_read_b64 v[14:15], v21 offset:4608
    s_waitcnt lgkmcnt(0)
    v_mfma_f32_16x16x32_bf16 v[152:155], v[24:27], v[56:59], 0
    ds_read2_b32 v[88:89], v17 offset0:16 offset1:17
    v_mfma_f32_16x16x32_bf16 v[156:159], v[28:31], v[56:59], 0
    ds_read2_b32 v[90:91], v17 offset0:18 offset1:19
    v_mfma_f32_16x16x32_bf16 v[160:163], v[32:35], v[56:59], 0
    ds_read_b128 v[120:123], v23 offset:3648
    v_mfma_f32_16x16x32_bf16 v[164:167], v[36:39], v[56:59], 0
    ds_read2_b32 v[92:93], v17 offset0:144 offset1:145
    v_mfma_f32_16x16x32_bf16 v[168:171], v[40:43], v[56:59], 0
    ds_read2_b32 v[94:95], v17 offset0:146 offset1:147
    v_mfma_f32_16x16x32_bf16 v[172:175], v[44:47], v[56:59], 0
    ds_read_b128 v[124:127], v23 offset:3136
    v_mfma_f32_16x16x32_bf16 v[176:179], v[48:51], v[56:59], 0
    ds_read2_b32 v[96:97], v18 offset0:16 offset1:17
    v_mfma_f32_16x16x32_bf16 v[180:183], v[52:55], v[56:59], 0
    ds_read2_b32 v[98:99], v18 offset0:18 offset1:19
    v_mfma_f32_16x16x32_bf16 v[156:159], v[24:27], v[60:63], v[156:159]
    ds_read_b128 v[128:131], v23 offset:2624
    v_mfma_f32_16x16x32_bf16 v[160:163], v[28:31], v[60:63], v[160:163]
    ds_read2_b32 v[100:101], v18 offset0:144 offset1:145
    v_mfma_f32_16x16x32_bf16 v[164:167], v[32:35], v[60:63], v[164:167]
    ds_read2_b32 v[102:103], v18 offset0:146 offset1:147
    v_mfma_f32_16x16x32_bf16 v[168:171], v[36:39], v[60:63], v[168:171]
    ds_read_b128 v[132:135], v23 offset:2112
    v_mfma_f32_16x16x32_bf16 v[172:175], v[40:43], v[60:63], v[172:175]
    ds_read2_b32 v[104:105], v19 offset0:16 offset1:17
    v_mfma_f32_16x16x32_bf16 v[176:179], v[44:47], v[60:63], v[176:179]
    ds_read2_b32 v[106:107], v19 offset0:18 offset1:19
    v_mfma_f32_16x16x32_bf16 v[180:183], v[48:51], v[60:63], v[180:183]
    ds_read_b128 v[136:139], v23 offset:1600
    v_mfma_f32_16x16x32_bf16 v[160:163], v[24:27], v[64:67], v[160:163]
    ds_read2_b32 v[108:109], v19 offset0:144 offset1:145
    v_mfma_f32_16x16x32_bf16 v[164:167], v[28:31], v[64:67], v[164:167]
    ds_read2_b32 v[110:111], v19 offset0:146 offset1:147
    v_mfma_f32_16x16x32_bf16 v[168:171], v[32:35], v[64:67], v[168:171]
    ds_read_b128 v[140:143], v23 offset:1088
    v_mfma_f32_16x16x32_bf16 v[172:175], v[36:39], v[64:67], v[172:175]
    ds_read2_b32 v[112:113], v20 offset0:16 offset1:17
    v_mfma_f32_16x16x32_bf16 v[176:179], v[40:43], v[64:67], v[176:179]
    ds_read2_b32 v[114:115], v20 offset0:18 offset1:19
    v_mfma_f32_16x16x32_bf16 v[180:183], v[44:47], v[64:67], v[180:183]
    ds_read_b128 v[144:147], v23 offset:576
    v_mfma_f32_16x16x32_bf16 v[164:167], v[24:27], v[68:71], v[164:167]
    ds_read2_b32 v[116:117], v20 offset0:144 offset1:145
    v_mfma_f32_16x16x32_bf16 v[168:171], v[28:31], v[68:71], v[168:171]
    ds_read2_b32 v[118:119], v20 offset0:146 offset1:147
    v_mfma_f32_16x16x32_bf16 v[172:175], v[32:35], v[68:71], v[172:175]
    ds_read_b128 v[148:151], v23 offset:64
    v_mfma_f32_16x16x32_bf16 v[176:179], v[36:39], v[68:71], v[176:179]
    v_mfma_f32_16x16x32_bf16 v[180:183], v[40:43], v[68:71], v[180:183]
    v_mfma_f32_16x16x32_bf16 v[168:171], v[24:27], v[72:75], v[168:171]
    v_mfma_f32_16x16x32_bf16 v[172:175], v[28:31], v[72:75], v[172:175]
    v_mfma_f32_16x16x32_bf16 v[176:179], v[32:35], v[72:75], v[176:179]
    v_mfma_f32_16x16x32_bf16 v[180:183], v[36:39], v[72:75], v[180:183]
    v_mfma_f32_16x16x32_bf16 v[172:175], v[24:27], v[76:79], v[172:175]
    v_mfma_f32_16x16x32_bf16 v[176:179], v[28:31], v[76:79], v[176:179]
    v_mfma_f32_16x16x32_bf16 v[180:183], v[32:35], v[76:79], v[180:183]
    v_mfma_f32_16x16x32_bf16 v[176:179], v[24:27], v[80:83], v[176:179]
    v_mfma_f32_16x16x32_bf16 v[180:183], v[28:31], v[80:83], v[180:183]
    v_mfma_f32_16x16x32_bf16 v[180:183], v[24:27], v[84:87], v[180:183]
    s_waitcnt lgkmcnt(0)
    v_mfma_f32_16x16x32_bf16 v[152:155], v[88:91], v[120:123], v[152:155]
    ds_read2_b32 v[24:25], v17 offset0:32 offset1:33
    v_mfma_f32_16x16x32_bf16 v[156:159], v[92:95], v[120:123], v[156:159]
    ds_read2_b32 v[26:27], v17 offset0:34 offset1:35
    v_mfma_f32_16x16x32_bf16 v[160:163], v[96:99], v[120:123], v[160:163]
    ds_read_b128 v[56:59], v23 offset:3712
    v_mfma_f32_16x16x32_bf16 v[164:167], v[100:103], v[120:123], v[164:167]
    ds_read2_b32 v[28:29], v17 offset0:160 offset1:161
    v_mfma_f32_16x16x32_bf16 v[168:171], v[104:107], v[120:123], v[168:171]
    ds_read2_b32 v[30:31], v17 offset0:162 offset1:163
    v_mfma_f32_16x16x32_bf16 v[172:175], v[108:111], v[120:123], v[172:175]
    ds_read_b128 v[60:63], v23 offset:3200
    v_mfma_f32_16x16x32_bf16 v[176:179], v[112:115], v[120:123], v[176:179]
    ds_read2_b32 v[32:33], v18 offset0:32 offset1:33
    v_mfma_f32_16x16x32_bf16 v[180:183], v[116:119], v[120:123], v[180:183]
    ds_read2_b32 v[34:35], v18 offset0:34 offset1:35
    v_mfma_f32_16x16x32_bf16 v[156:159], v[88:91], v[124:127], v[156:159]
    ds_read_b128 v[64:67], v23 offset:2688
    v_mfma_f32_16x16x32_bf16 v[160:163], v[92:95], v[124:127], v[160:163]
    ds_read2_b32 v[36:37], v18 offset0:160 offset1:161
    v_mfma_f32_16x16x32_bf16 v[164:167], v[96:99], v[124:127], v[164:167]
    ds_read2_b32 v[38:39], v18 offset0:162 offset1:163
    v_mfma_f32_16x16x32_bf16 v[168:171], v[100:103], v[124:127], v[168:171]
    ds_read_b128 v[68:71], v23 offset:2176
    v_mfma_f32_16x16x32_bf16 v[172:175], v[104:107], v[124:127], v[172:175]
    ds_read2_b32 v[40:41], v19 offset0:32 offset1:33
    v_mfma_f32_16x16x32_bf16 v[176:179], v[108:111], v[124:127], v[176:179]
    ds_read2_b32 v[42:43], v19 offset0:34 offset1:35
    v_mfma_f32_16x16x32_bf16 v[180:183], v[112:115], v[124:127], v[180:183]
    ds_read_b128 v[72:75], v23 offset:1664
    v_mfma_f32_16x16x32_bf16 v[160:163], v[88:91], v[128:131], v[160:163]
    ds_read2_b32 v[44:45], v19 offset0:160 offset1:161
    v_mfma_f32_16x16x32_bf16 v[164:167], v[92:95], v[128:131], v[164:167]
    ds_read2_b32 v[46:47], v19 offset0:162 offset1:163
    v_mfma_f32_16x16x32_bf16 v[168:171], v[96:99], v[128:131], v[168:171]
    ds_read_b128 v[76:79], v23 offset:1152
    v_mfma_f32_16x16x32_bf16 v[172:175], v[100:103], v[128:131], v[172:175]
    ds_read2_b32 v[48:49], v20 offset0:32 offset1:33
    v_mfma_f32_16x16x32_bf16 v[176:179], v[104:107], v[128:131], v[176:179]
    ds_read2_b32 v[50:51], v20 offset0:34 offset1:35
    v_mfma_f32_16x16x32_bf16 v[180:183], v[108:111], v[128:131], v[180:183]
    ds_read_b128 v[80:83], v23 offset:640
    v_mfma_f32_16x16x32_bf16 v[164:167], v[88:91], v[132:135], v[164:167]
    ds_read2_b32 v[52:53], v20 offset0:160 offset1:161
    v_mfma_f32_16x16x32_bf16 v[168:171], v[92:95], v[132:135], v[168:171]
    ds_read2_b32 v[54:55], v20 offset0:162 offset1:163
    v_mfma_f32_16x16x32_bf16 v[172:175], v[96:99], v[132:135], v[172:175]
    ds_read_b128 v[84:87], v23 offset:128
    v_mfma_f32_16x16x32_bf16 v[176:179], v[100:103], v[132:135], v[176:179]
    v_mfma_f32_16x16x32_bf16 v[180:183], v[104:107], v[132:135], v[180:183]
    v_mfma_f32_16x16x32_bf16 v[168:171], v[88:91], v[136:139], v[168:171]
    v_mfma_f32_16x16x32_bf16 v[172:175], v[92:95], v[136:139], v[172:175]
    v_mfma_f32_16x16x32_bf16 v[176:179], v[96:99], v[136:139], v[176:179]
    v_mfma_f32_16x16x32_bf16 v[180:183], v[100:103], v[136:139], v[180:183]
    v_mfma_f32_16x16x32_bf16 v[172:175], v[88:91], v[140:143], v[172:175]
    v_mfma_f32_16x16x32_bf16 v[176:179], v[92:95], v[140:143], v[176:179]
    v_mfma_f32_16x16x32_bf16 v[180:183], v[96:99], v[140:143], v[180:183]
    v_mfma_f32_16x16x32_bf16 v[176:179], v[88:91], v[144:147], v[176:179]
    v_mfma_f32_16x16x32_bf16 v[180:183], v[92:95], v[144:147], v[180:183]
    v_mfma_f32_16x16x32_bf16 v[180:183], v[88:91], v[148:151], v[180:183]
    s_waitcnt lgkmcnt(0)
    v_mfma_f32_16x16x32_bf16 v[152:155], v[24:27], v[56:59], v[152:155]
    ds_read2_b32 v[88:89], v17 offset0:48 offset1:49
    v_mfma_f32_16x16x32_bf16 v[156:159], v[28:31], v[56:59], v[156:159]
    ds_read2_b32 v[90:91], v17 offset0:50 offset1:51
    v_mfma_f32_16x16x32_bf16 v[160:163], v[32:35], v[56:59], v[160:163]
    ds_read_b128 v[120:123], v23 offset:3776
    v_mfma_f32_16x16x32_bf16 v[164:167], v[36:39], v[56:59], v[164:167]
    ds_read2_b32 v[92:93], v17 offset0:176 offset1:177
    v_mfma_f32_16x16x32_bf16 v[168:171], v[40:43], v[56:59], v[168:171]
    ds_read2_b32 v[94:95], v17 offset0:178 offset1:179
    v_mfma_f32_16x16x32_bf16 v[172:175], v[44:47], v[56:59], v[172:175]
    ds_read_b128 v[124:127], v23 offset:3264
    v_mfma_f32_16x16x32_bf16 v[176:179], v[48:51], v[56:59], v[176:179]
    ds_read2_b32 v[96:97], v18 offset0:48 offset1:49
    v_mfma_f32_16x16x32_bf16 v[180:183], v[52:55], v[56:59], v[180:183]
    ds_read2_b32 v[98:99], v18 offset0:50 offset1:51
    v_mfma_f32_16x16x32_bf16 v[156:159], v[24:27], v[60:63], v[156:159]
    ds_read_b128 v[128:131], v23 offset:2752
    v_mfma_f32_16x16x32_bf16 v[160:163], v[28:31], v[60:63], v[160:163]
    ds_read2_b32 v[100:101], v18 offset0:176 offset1:177
    v_mfma_f32_16x16x32_bf16 v[164:167], v[32:35], v[60:63], v[164:167]
    ds_read2_b32 v[102:103], v18 offset0:178 offset1:179
    v_mfma_f32_16x16x32_bf16 v[168:171], v[36:39], v[60:63], v[168:171]
    ds_read_b128 v[132:135], v23 offset:2240
    v_mfma_f32_16x16x32_bf16 v[172:175], v[40:43], v[60:63], v[172:175]
    ds_read2_b32 v[104:105], v19 offset0:48 offset1:49
    v_mfma_f32_16x16x32_bf16 v[176:179], v[44:47], v[60:63], v[176:179]
    ds_read2_b32 v[106:107], v19 offset0:50 offset1:51
    v_mfma_f32_16x16x32_bf16 v[180:183], v[48:51], v[60:63], v[180:183]
    ds_read_b128 v[136:139], v23 offset:1728
    v_mfma_f32_16x16x32_bf16 v[160:163], v[24:27], v[64:67], v[160:163]
    ds_read2_b32 v[108:109], v19 offset0:176 offset1:177
    v_mfma_f32_16x16x32_bf16 v[164:167], v[28:31], v[64:67], v[164:167]
    ds_read2_b32 v[110:111], v19 offset0:178 offset1:179
    v_mfma_f32_16x16x32_bf16 v[168:171], v[32:35], v[64:67], v[168:171]
    ds_read_b128 v[140:143], v23 offset:1216
    v_mfma_f32_16x16x32_bf16 v[172:175], v[36:39], v[64:67], v[172:175]
    ds_read2_b32 v[112:113], v20 offset0:48 offset1:49
    v_mfma_f32_16x16x32_bf16 v[176:179], v[40:43], v[64:67], v[176:179]
    ds_read2_b32 v[114:115], v20 offset0:50 offset1:51
    v_mfma_f32_16x16x32_bf16 v[180:183], v[44:47], v[64:67], v[180:183]
    ds_read_b128 v[144:147], v23 offset:704
    v_mfma_f32_16x16x32_bf16 v[164:167], v[24:27], v[68:71], v[164:167]
    ds_read2_b32 v[116:117], v20 offset0:176 offset1:177
    v_mfma_f32_16x16x32_bf16 v[168:171], v[28:31], v[68:71], v[168:171]
    ds_read2_b32 v[118:119], v20 offset0:178 offset1:179
    v_mfma_f32_16x16x32_bf16 v[172:175], v[32:35], v[68:71], v[172:175]
    ds_read_b128 v[148:151], v23 offset:192
    v_mfma_f32_16x16x32_bf16 v[176:179], v[36:39], v[68:71], v[176:179]
    v_mfma_f32_16x16x32_bf16 v[180:183], v[40:43], v[68:71], v[180:183]
    v_mfma_f32_16x16x32_bf16 v[168:171], v[24:27], v[72:75], v[168:171]
    v_mfma_f32_16x16x32_bf16 v[172:175], v[28:31], v[72:75], v[172:175]
    v_mfma_f32_16x16x32_bf16 v[176:179], v[32:35], v[72:75], v[176:179]
    v_mfma_f32_16x16x32_bf16 v[180:183], v[36:39], v[72:75], v[180:183]
    v_mfma_f32_16x16x32_bf16 v[172:175], v[24:27], v[76:79], v[172:175]
    v_mfma_f32_16x16x32_bf16 v[176:179], v[28:31], v[76:79], v[176:179]
    v_mfma_f32_16x16x32_bf16 v[180:183], v[32:35], v[76:79], v[180:183]
    v_mfma_f32_16x16x32_bf16 v[176:179], v[24:27], v[80:83], v[176:179]
    v_mfma_f32_16x16x32_bf16 v[180:183], v[28:31], v[80:83], v[180:183]
    v_mfma_f32_16x16x32_bf16 v[180:183], v[24:27], v[84:87], v[180:183]
    s_waitcnt lgkmcnt(0)
    v_mfma_f32_16x16x32_bf16 v[152:155], v[88:91], v[120:123], v[152:155]
    v_mfma_f32_16x16x32_bf16 v[156:159], v[92:95], v[120:123], v[156:159]
    v_mfma_f32_16x16x32_bf16 v[160:163], v[96:99], v[120:123], v[160:163]
    v_mfma_f32_16x16x32_bf16 v[164:167], v[100:103], v[120:123], v[164:167]
    v_mfma_f32_16x16x32_bf16 v[168:171], v[104:107], v[120:123], v[168:171]
    v_mfma_f32_16x16x32_bf16 v[172:175], v[108:111], v[120:123], v[172:175]
    v_mfma_f32_16x16x32_bf16 v[176:179], v[112:115], v[120:123], v[176:179]
    v_mfma_f32_16x16x32_bf16 v[180:183], v[116:119], v[120:123], v[180:183]
    v_mfma_f32_16x16x32_bf16 v[156:159], v[88:91], v[124:127], v[156:159]
    v_mfma_f32_16x16x32_bf16 v[160:163], v[92:95], v[124:127], v[160:163]
    v_mfma_f32_16x16x32_bf16 v[164:167], v[96:99], v[124:127], v[164:167]
    v_mfma_f32_16x16x32_bf16 v[168:171], v[100:103], v[124:127], v[168:171]
    v_mfma_f32_16x16x32_bf16 v[172:175], v[104:107], v[124:127], v[172:175]
    v_mfma_f32_16x16x32_bf16 v[176:179], v[108:111], v[124:127], v[176:179]
    v_mfma_f32_16x16x32_bf16 v[180:183], v[112:115], v[124:127], v[180:183]
    v_mfma_f32_16x16x32_bf16 v[160:163], v[88:91], v[128:131], v[160:163]
    v_mfma_f32_16x16x32_bf16 v[164:167], v[92:95], v[128:131], v[164:167]
    v_mfma_f32_16x16x32_bf16 v[168:171], v[96:99], v[128:131], v[168:171]
    v_mfma_f32_16x16x32_bf16 v[172:175], v[100:103], v[128:131], v[172:175]
    v_mfma_f32_16x16x32_bf16 v[176:179], v[104:107], v[128:131], v[176:179]
    v_mfma_f32_16x16x32_bf16 v[180:183], v[108:111], v[128:131], v[180:183]
    v_mfma_f32_16x16x32_bf16 v[164:167], v[88:91], v[132:135], v[164:167]
    v_mfma_f32_16x16x32_bf16 v[168:171], v[92:95], v[132:135], v[168:171]
    v_mfma_f32_16x16x32_bf16 v[172:175], v[96:99], v[132:135], v[172:175]
    v_mfma_f32_16x16x32_bf16 v[176:179], v[100:103], v[132:135], v[176:179]
    v_mfma_f32_16x16x32_bf16 v[180:183], v[104:107], v[132:135], v[180:183]
    v_mfma_f32_16x16x32_bf16 v[168:171], v[88:91], v[136:139], v[168:171]
    v_mfma_f32_16x16x32_bf16 v[172:175], v[92:95], v[136:139], v[172:175]
    v_mfma_f32_16x16x32_bf16 v[176:179], v[96:99], v[136:139], v[176:179]
    v_mfma_f32_16x16x32_bf16 v[180:183], v[100:103], v[136:139], v[180:183]
    v_mfma_f32_16x16x32_bf16 v[172:175], v[88:91], v[140:143], v[172:175]
    v_mfma_f32_16x16x32_bf16 v[176:179], v[92:95], v[140:143], v[176:179]
    v_mfma_f32_16x16x32_bf16 v[180:183], v[96:99], v[140:143], v[180:183]
    v_mfma_f32_16x16x32_bf16 v[176:179], v[88:91], v[144:147], v[176:179]
    v_mfma_f32_16x16x32_bf16 v[180:183], v[92:95], v[144:147], v[180:183]
    v_mfma_f32_16x16x32_bf16 v[180:183], v[88:91], v[148:151], v[180:183]
    v_mov_b32 v186, 160768
    v_mov_b32 v187, 1
    s_mov_b64 exec, 1
    s_waitcnt lgkmcnt(0)
    ds_add_u32 v186, v187 offset:16
    s_mov_b64 exec, 1
    s_mov_b64 exec, 1
    s_mov_b32 s39, 0
CV_SA:
    ds_read_b32 v187, v186 offset:16
    s_add_u32 s39, s39, 1
    s_waitcnt lgkmcnt(0)
    v_cmp_gt_u32 vcc, 4, v187
    s_cmp_ge_u32 s39, 3200000
    s_cbranch_scc1 CV_SA_D
    s_cbranch_vccz CV_SA_D
    s_sleep 1
    s_branch CV_SA
CV_SA_D:
    s_mov_b64 exec, -1
    s_cmp_eq_u32 s34, 0
    s_cbranch_scc0 CV_H1
    ds_write_b128 v184, v[168:171] offset:0
    ds_write_b128 v184, v[172:175] offset:1024
    ds_write_b128 v184, v[176:179] offset:2048
    ds_write_b128 v184, v[180:183] offset:3072
    v_mov_b32 v24, v152
    v_mov_b32 v25, v153
    v_mov_b32 v26, v154
    v_mov_b32 v27, v155
    v_mov_b32 v28, v156
    v_mov_b32 v29, v157
    v_mov_b32 v30, v158
    v_mov_b32 v31, v159
    v_mov_b32 v32, v160
    v_mov_b32 v33, v161
    v_mov_b32 v34, v162
    v_mov_b32 v35, v163
    v_mov_b32 v36, v164
    v_mov_b32 v37, v165
    v_mov_b32 v38, v166
    v_mov_b32 v39, v167
    s_branch CV_H2
CV_H1:
    ds_write_b128 v184, v[152:155] offset:0
    ds_write_b128 v184, v[156:159] offset:1024
    ds_write_b128 v184, v[160:163] offset:2048
    ds_write_b128 v184, v[164:167] offset:3072
    v_mov_b32 v24, v168
    v_mov_b32 v25, v169
    v_mov_b32 v26, v170
    v_mov_b32 v27, v171
    v_mov_b32 v28, v172
    v_mov_b32 v29, v173
    v_mov_b32 v30, v174
    v_mov_b32 v31, v175
    v_mov_b32 v32, v176
    v_mov_b32 v33, v177
    v_mov_b32 v34, v178
    v_mov_b32 v35, v179
    v_mov_b32 v36, v180
    v_mov_b32 v37, v181
    v_mov_b32 v38, v182
    v_mov_b32 v39, v183
CV_H2:
    v_mov_b32 v186, s44
    v_mov_b32 v187, 1
    s_mov_b64 exec, 1
    s_waitcnt lgkmcnt(0)
    ds_add_u32 v186, v187 offset:0
    s_mov_b64 exec, 1
    s_mov_b64 exec, 1
    s_mov_b32 s39, 0
CV_SB:
    ds_read_b32 v187, v186 offset:0
    s_add_u32 s39, s39, 1
    s_waitcnt lgkmcnt(0)
    v_cmp_gt_u32 vcc, 2, v187
    s_cmp_ge_u32 s39, 3200000
    s_cbranch_scc1 CV_SB_D
    s_cbranch_vccz CV_SB_D
    s_sleep 1
    s_branch CV_SB
CV_SB_D:
    s_mov_b64 exec, -1
    ds_read_b128 v[40:43], v185 offset:0
    ds_read_b128 v[44:47], v185 offset:1024
    ds_read_b128 v[48:51], v185 offset:2048
    ds_read_b128 v[52:55], v185 offset:3072
    s_waitcnt lgkmcnt(0)
    s_cmp_eq_u32 s33, 0
    s_cbranch_scc0 CV_C1
    v_add_f32 v32, v32, v48
    v_add_f32 v33, v33, v49
    v_add_f32 v34, v34, v50
    v_add_f32 v35, v35, v51
    v_add_f32 v36, v36, v52
    v_add_f32 v37, v37, v53
    v_add_f32 v38, v38, v54
    v_add_f32 v39, v39, v55
    ds_write_b128 v190, v[32:35] offset:0
    ds_write_b128 v190, v[36:39] offset:1024
    v_add_f32 v56, v24, v40
    v_add_f32 v57, v25, v41
    v_add_f32 v58, v26, v42
    v_add_f32 v59, v27, v43
    v_add_f32 v60, v28, v44
    v_add_f32 v61, v29, v45
    v_add_f32 v62, v30, v46
    v_add_f32 v63, v31, v47
    v_mov_b32 v186, s45
    v_mov_b32 v187, 1
    s_mov_b64 exec, 1
    s_waitcnt lgkmcnt(0)
    ds_add_u32 v186, v187 offset:0
    s_mov_b64 exec, 1
    s_mov_b64 exec, 1
    s_mov_b32 s39, 0
CV_SC0:
    ds_read_b32 v187, v186 offset:0
    s_add_u32 s39, s39, 1
    s_waitcnt lgkmcnt(0)
    v_cmp_gt_u32 vcc, 2, v187
    s_cmp_ge_u32 s39, 3200000
    s_cbranch_scc1 CV_SC0_D
    s_cbranch_vccz CV_SC0_D
    s_sleep 1
    s_branch CV_SC0
CV_SC0_D:
    s_mov_b64 exec, -1
    ds_read_b128 v[64:67], v191 offset:0
    ds_read_b128 v[68:71], v191 offset:1024
    s_branch CV_C2
CV_C1:
    v_add_f32 v24, v24, v40
    v_add_f32 v25, v25, v41
    v_add_f32 v26, v26, v42
    v_add_f32 v27, v27, v43
    v_add_f32 v28, v28, v44
    v_add_f32 v29, v29, v45
    v_add_f32 v30, v30, v46
    v_add_f32 v31, v31, v47
    ds_write_b128 v190, v[24:27] offset:0
    ds_write_b128 v190, v[28:31] offset:1024
    v_add_f32 v64, v32, v48
    v_add_f32 v65, v33, v49
    v_add_f32 v66, v34, v50
    v_add_f32 v67, v35, v51
    v_add_f32 v68, v36, v52
    v_add_f32 v69, v37, v53
    v_add_f32 v70, v38, v54
    v_add_f32 v71, v39, v55
    v_mov_b32 v186, s45
    v_mov_b32 v187, 1
    s_mov_b64 exec, 1
    s_waitcnt lgkmcnt(0)
    ds_add_u32 v186, v187 offset:0
    s_mov_b64 exec, 1
    s_mov_b64 exec, 1
    s_mov_b32 s39, 0
CV_SC1:
    ds_read_b32 v187, v186 offset:0
    s_add_u32 s39, s39, 1
    s_waitcnt lgkmcnt(0)
    v_cmp_gt_u32 vcc, 2, v187
    s_cmp_ge_u32 s39, 3200000
    s_cbranch_scc1 CV_SC1_D
    s_cbranch_vccz CV_SC1_D
    s_sleep 1
    s_branch CV_SC1
CV_SC1_D:
    s_mov_b64 exec, -1
    ds_read_b128 v[56:59], v191 offset:0
    ds_read_b128 v[60:63], v191 offset:1024
CV_C2:
    s_waitcnt lgkmcnt(0)
    v_and_b32 v188, 0xffff0000, v9
    v_fma_f32 v56, v188, v6, v56
    v_and_b32 v189, 0xffff0000, v11
    v_fma_f32 v64, v189, v7, v64
    v_cvt_pk_bf16_f32 v192, v56, v64
    buffer_store_dword v192, v4, s[16:19], s40 offen offset:0
    v_lshlrev_b32 v188, 16, v9
    v_fma_f32 v57, v188, v6, v57
    v_lshlrev_b32 v189, 16, v11
    v_fma_f32 v65, v189, v7, v65
    v_cvt_pk_bf16_f32 v193, v57, v65
    buffer_store_dword v193, v4, s[16:19], s40 offen offset:2048
    v_and_b32 v188, 0xffff0000, v8
    v_fma_f32 v58, v188, v6, v58
    v_and_b32 v189, 0xffff0000, v10
    v_fma_f32 v66, v189, v7, v66
    v_cvt_pk_bf16_f32 v194, v58, v66
    buffer_store_dword v194, v4, s[16:19], s41 offen offset:0
    v_lshlrev_b32 v188, 16, v8
    v_fma_f32 v59, v188, v6, v59
    v_lshlrev_b32 v189, 16, v10
    v_fma_f32 v67, v189, v7, v67
    v_cvt_pk_bf16_f32 v195, v59, v67
    buffer_store_dword v195, v4, s[16:19], s41 offen offset:2048
    v_and_b32 v188, 0xffff0000, v13
    v_fma_f32 v60, v188, v6, v60
    v_and_b32 v189, 0xffff0000, v15
    v_fma_f32 v68, v189, v7, v68
    v_cvt_pk_bf16_f32 v196, v60, v68
    buffer_store_dword v196, v4, s[16:19], s42 offen offset:0
    v_lshlrev_b32 v188, 16, v13
    v_fma_f32 v61, v188, v6, v61
    v_lshlrev_b32 v189, 16, v15
    v_fma_f32 v69, v189, v7, v69
    v_cvt_pk_bf16_f32 v197, v61, v69
    buffer_store_dword v197, v4, s[16:19], s42 offen offset:2048
    v_and_b32 v188, 0xffff0000, v12
    v_fma_f32 v62, v188, v6, v62
    v_and_b32 v189, 0xffff0000, v14
    v_fma_f32 v70, v189, v7, v70
    v_cvt_pk_bf16_f32 v198, v62, v70
    buffer_store_dword v198, v4, s[16:19], s43 offen offset:0
    v_lshlrev_b32 v188, 16, v12
    v_fma_f32 v63, v188, v6, v63
    v_lshlrev_b32 v189, 16, v14
    v_fma_f32 v71, v189, v7, v71
    v_cvt_pk_bf16_f32 v199, v63, v71
    buffer_store_dword v199, v4, s[16:19], s43 offen offset:2048
K_END:
    s_endpgm
.section .rodata,"a"
.p2align 6
.amdhsa_kernel concat_heads__softmax_full_mha__ssm_conv_s4__prompt_kernel
  .amdhsa_next_free_vgpr 256
  .amdhsa_next_free_sgpr 102
  .amdhsa_accum_offset 256
  .amdhsa_group_segment_fixed_size 0
  .amdhsa_kernarg_size 120
  .amdhsa_user_sgpr_count 2
  .amdhsa_user_sgpr_kernarg_segment_ptr 1
  .amdhsa_system_sgpr_workgroup_id_x 1
.end_amdhsa_kernel
```
